```python
import torch

def _softmax(x, axis=-1):
    return torch.softmax(x, dim=axis)
def _gelu(x):
    return torch.nn.functional.gelu(x, approximate="tanh")
def _silu(x):
    return torch.nn.functional.silu(x)
def _sigmoid(x):
    return torch.sigmoid(x)
def _layernorm(x, axis=-1, eps=1e-5):
    m = x.mean(dim=axis, keepdim=True)
    v = x.var(dim=axis, keepdim=True, unbiased=False)
    return (x - m) / torch.sqrt(v + eps)
def _scatter_add(tgt, idx, src, axis=0):
    return tgt.clone().index_add_(axis, idx, src)
def _segment_sum(src, seg, n):
    out = torch.zeros((n,) + src.shape[1:], dtype=src.dtype)
    return out.index_add_(0, seg, src)
def _pad(x, pw):
    flat = tuple(v for pair in reversed(pw) for v in pair)
    return torch.nn.functional.pad(x, flat)

kernel_name = 'recurrent_scan__mha_block_cached__geglu_ffn__decode'

def setup_inputs():

    _w = (lambda a: (lambda t: t.to(torch.bfloat16) if t.is_floating_point() else t)(torch.as_tensor(a)))
    def _A_setup():
        B, Sq, D = 4, 1, 640
        H, Sk, Dh = 32, 8192, 192
        return {
            "x": _w((lambda *s: torch.randn(*s, dtype=torch.bfloat16) * 0.05)(B, Sq, D)),
            "k_cache": _w((lambda *s: torch.randn(*s, dtype=torch.bfloat16) * 1.6)(B, H, Sk, Dh)),
            "v_cache": _w((lambda *s: torch.randn(*s, dtype=torch.bfloat16) * 0.2)(B, H, Sk, Dh)),
            "wq": _w((lambda *s: torch.randn(*s, dtype=torch.bfloat16) * 1.6)(D, H * Dh) * (D ** -0.5)),
            "wo": _w((lambda *s: torch.randn(*s, dtype=torch.bfloat16) * 0.2)(H * Dh, D) * ((H * Dh) ** -0.5)),
        }
    _A_in = _A_setup()

    def _B_setup():
        B, S, D, F = 4, 1, 640, 1536
        return {
            "x": _w((lambda *s: torch.randn(*s, dtype=torch.bfloat16) * 0.05)(B, S, D)),
            "w_gate": _w((lambda *s: torch.randn(*s, dtype=torch.bfloat16) * 0.1)(D, F)),
            "w_up": _w((lambda *s: torch.randn(*s, dtype=torch.bfloat16) * 0.1)(D, F)),
            "w_down": _w((lambda *s: torch.randn(*s, dtype=torch.bfloat16) * 0.1)(F, D)),
        }
    _B_in = _B_setup()

    return {
        "A_x": _A_in["x"],
        "A_k_cache": _A_in["k_cache"],
        "A_v_cache": _A_in["v_cache"],
        "A_wq": _A_in["wq"],
        "A_wo": _A_in["wo"],
        "B_x": _B_in["x"],
        "B_w_gate": _B_in["w_gate"],
        "B_w_up": _B_in["w_up"],
        "B_w_down": _B_in["w_down"],
    }

def reference(A_x, A_k_cache, A_v_cache, A_wq, A_wo, B_x, B_w_gate, B_w_up, B_w_down):
    def _A_ref(x, k_cache, v_cache, wq, wo):
        B, Sq, D = x.shape
        H, Dh = 32, 192
        q = (lambda x, *d: x.permute(*d))((x @ wq).reshape(B, Sq, H, Dh), 0, 2, 1, 3)
        scores = torch.einsum("bhqd,bhkd->bhqk", q, k_cache) * (Dh ** -0.5)
        p = _softmax(scores, axis=-1)
        o = torch.einsum("bhqk,bhkd->bhqd", p, v_cache)
        return (lambda x, *d: x.permute(*d))(o, 0, 2, 1, 3).reshape(B, Sq, H * Dh) @ wo

    def _B_ref(x, w_gate, w_up, w_down):
        return (_gelu(x @ w_gate) * (x @ w_up)) @ w_down

    x = A_x
    xn = _layernorm(x, axis=-1)
    s = _A_ref(xn, A_k_cache, A_v_cache, A_wq, A_wo)
    g = _silu(_B_ref(xn, B_w_gate, B_w_up, B_w_down))
    return x + s * g
```

```asm
; @launch grid=(256,1,1) block=(512,1,1) lds=158992
.amdgcn_target "amdgcn-amd-amdhsa--gfx950"
.text
.globl recurrent_scan__mha_block_cached__geglu_ffn__decode_kernel
.p2align 8
.type recurrent_scan__mha_block_cached__geglu_ffn__decode_kernel,@function
recurrent_scan__mha_block_cached__geglu_ffn__decode_kernel:
    s_cmp_ge_u32 s2, 256
    s_cbranch_scc1 L_END
    s_load_dwordx16 s[44:59], s[0:1], 0
    s_load_dwordx8 s[60:67], s[0:1], 64
    v_and_b32 v1, 63, v0
    v_lshrrev_b32 v54, 6, v0
    s_nop 0
    v_readfirstlane_b32 s3, v54
    s_lshr_b32 s4, s2, 3
    s_and_b32 s5, s2, 7
    v_lshrrev_b32 v54, 3, v1
    v_mul_u32_u24 v2, 384, v54
    v_and_b32 v55, 7, v1
    v_lshlrev_b32 v56, 4, v55
    v_add_u32 v2, v2, v56
    v_lshlrev_b32 v14, 3, v55
    v_add_u32 v14, v14, v54
    v_lshlrev_b32 v14, 2, v14
    v_add_u32 v15, 136320, v56
    v_mov_b32 v4, 1
    s_lshl_b32 s33, s4, 10
    v_mov_b32 v3, s33
    s_mul_i32 s30, s4, 3145728
    s_mul_i32 s74, s5, 56
    s_add_u32 s74, s74, s3
    v_mov_b32 v5, 139520
    s_mov_b32 s6, 0
    s_mov_b32 s7, 0
    s_mov_b32 s24, 12288
    s_mov_b32 s25, 0
    s_mov_b32 s26, 0
    s_mov_b32 s27, 0
    s_mov_b32 s29, 0
    s_cmp_lt_u32 s5, 3
    s_cbranch_scc1 L_roleA
    s_cmp_eq_u32 s5, 3
    s_cbranch_scc1 L_roleB3
    s_cmp_eq_u32 s5, 4
    s_cbranch_scc1 L_roleB4
    s_cmp_eq_u32 s5, 7
    s_cbranch_scc1 L_roledone
    s_cmp_lt_u32 s4, 16
    s_cbranch_scc1 L_roledone
    s_sub_u32 s33, s4, 16
    s_lshl_b32 s33, s33, 1
    s_add_u32 s33, s33, s5
    s_sub_u32 s33, s33, 5
    s_cmp_ge_u32 s33, 30
    s_cbranch_scc1 L_roledone
    s_mov_b32 s6, 2
    s_mov_b32 s7, 3
    s_cmp_ge_u32 s33, 10
    s_cselect_b32 s29, 1, 0
    s_cmp_ge_u32 s33, 20
    s_cselect_b32 s29, 2, s29
    s_mul_i32 s34, s29, 10
    s_sub_u32 s33, s33, s34
    s_mov_b32 s24, 1280
    s_mul_i32 s25, s29, 655360
    s_lshl_b32 s34, s33, 7
    s_add_u32 s25, s25, s34
    s_mul_i32 s26, s29, 10240
    s_lshl_b32 s34, s33, 8
    s_add_u32 s26, s26, s34
    s_add_u32 s26, s26, 1327104
    s_mov_b32 s27, 2560
    s_branch L_roledone
L_roleA:
    s_mov_b32 s6, 1
    s_mul_i32 s25, s4, 384
    s_lshl_b32 s34, s5, 7
    s_add_u32 s25, s25, s34
    s_mul_i32 s26, s4, 3072
    s_lshl_b32 s34, s5, 10
    s_add_u32 s26, s26, s34
    s_add_u32 s26, s26, 32768
    s_branch L_roledone
L_roleB4:
    s_cmp_ge_u32 s4, 16
    s_cbranch_scc1 L_roledone
    s_add_u32 s33, s4, 32
    s_branch L_roleB
L_roleB3:
    s_mov_b32 s33, s4
L_roleB:
    s_mov_b32 s6, 1
    s_lshl_b32 s26, s33, 10
    s_add_u32 s26, s26, 131072
    s_cmp_lt_u32 s33, 24
    s_cselect_b32 s7, 1, 2
    s_cselect_b32 s34, 0, 24
    s_sub_u32 s33, s33, s34
    s_mov_b32 s24, 3072
    s_lshl_b32 s25, s33, 7
L_roledone:
    s_waitcnt lgkmcnt(0)
    s_mov_b32 s8, s46
    s_mov_b32 s9, s47
    s_mov_b32 s10, 402653184
    s_mov_b32 s11, 0x20000
    s_mov_b32 s12, s48
    s_mov_b32 s13, s49
    s_mov_b32 s14, 402653184
    s_mov_b32 s15, 0x20000
    s_mov_b32 s16, s66
    s_mov_b32 s17, s67
    s_mov_b32 s18, 4194304
    s_mov_b32 s19, 0x20000
    s_mov_b32 s33, 4194048
    s_load_dwordx2 s[68:69], s[66:67], s33
    s_cmp_lt_u32 s3, 4
    s_cbranch_scc1 L_lo_waves
    v_subrev_u32 v16, 256, v0
    v_mov_b32 v20, -1
    v_mov_b32 v21, -1
    v_mov_b32 v22, -1
    v_mov_b32 v23, -1
    v_lshlrev_b32 v17, 4, v16
    s_lshl_b32 s33, s4, 3
    s_add_u32 s33, s33, s5
    s_mul_i32 s33, s33, 3200
    s_add_u32 s33, s33, 180224
    v_cmp_gt_u32 vcc, 200, v16
    s_and_saveexec_b64 s[38:39], vcc
    s_cbranch_execz L_clr1
    buffer_store_dwordx4 v[20:23], v17, s[16:19], s33 offen sc1
L_clr1:
    s_mov_b64 exec, s[38:39]
    s_cmp_lt_u32 s5, 5
    s_cbranch_scc0 L_clr2e
    s_mul_i32 s33, s4, 10240
    s_lshl_b32 s34, s5, 9
    s_add_u32 s33, s33, s34
    s_add_u32 s33, s33, 999424
    v_lshrrev_b32 v18, 5, v16
    v_mul_u32_u24 v18, 2560, v18
    v_and_b32 v19, 31, v16
    v_lshlrev_b32 v19, 4, v19
    v_add_u32 v18, v18, v19
    v_cmp_gt_u32 vcc, 128, v16
    s_and_saveexec_b64 s[38:39], vcc
    s_cbranch_execz L_clr2
    buffer_store_dwordx4 v[20:23], v18, s[16:19], s33 offen sc1
L_clr2:
    s_mov_b64 exec, s[38:39]
L_clr2e:
    s_cmp_eq_u32 s3, 7
    s_cbranch_scc0 L_hi_stream
L_w7init:
    v_mov_b32 v20, -1
    v_mov_b32 v21, -1
    v_mov_b32 v22, -1
    v_mov_b32 v23, -1
    v_lshlrev_b32 v16, 4, v1
    v_add_u32 v16, 139536, v16
    ds_write_b128 v16, v[20:23] offset:0
    ds_write_b128 v16, v[20:23] offset:1024
    ds_write_b128 v16, v[20:23] offset:2048
    ds_write_b128 v16, v[20:23] offset:3072
    ds_write_b128 v16, v[20:23] offset:4096
    ds_write_b128 v16, v[20:23] offset:5120
    ds_write_b128 v16, v[20:23] offset:6144
    ds_write_b128 v16, v[20:23] offset:7168
    ds_write_b128 v16, v[20:23] offset:8192
    ds_write_b128 v16, v[20:23] offset:9216
    ds_write_b128 v16, v[20:23] offset:10240
    ds_write_b128 v16, v[20:23] offset:11264
    ds_write_b128 v16, v[20:23] offset:12288
    ds_write_b128 v16, v[20:23] offset:13312
    ds_write_b128 v16, v[20:23] offset:14336
    ds_write_b128 v16, v[20:23] offset:15360
    ds_write_b128 v16, v[20:23] offset:16384
    ds_write_b128 v16, v[20:23] offset:17408
    s_mul_i32 s33, s5, 32
    s_add_u32 s33, s33, 448
    v_add_u32 v17, s33, v1
    v_lshlrev_b32 v18, 2, v1
    v_add_u32 v18, 139536, v18
    v_cmp_gt_u32 vcc, 32, v1
    s_and_saveexec_b64 s[38:39], vcc
    ds_write_b32 v18, v17
    s_mov_b64 exec, s[38:39]
    v_mov_b32 v17, 0
    ds_write_b32 v5, v17
    ds_write_b32 v5, v17 offset:8
    s_waitcnt lgkmcnt(0)
    s_cmp_eq_u32 s6, 1
    s_cbranch_scc0 L_w7_nob1
    s_barrier
L_w7_nob1:
    s_waitcnt vmcnt(0)
    s_setprio 3
    s_branch L_w0_q
    s_branch L_pre_b3
L_hi_stream:
    s_cmp_eq_u32 s6, 1
    s_cbranch_scc0 L_hi_r0
    s_add_u32 s32, s74, 0
    s_mul_i32 s32, s32, 3072
    s_add_u32 s32, s32, s30
    buffer_load_dwordx4 v[64:67], v2, s[8:11], s32 offen offset:0 nt
    buffer_load_dwordx4 v[68:71], v2, s[8:11], s32 offen offset:128 nt
    buffer_load_dwordx4 v[72:75], v2, s[8:11], s32 offen offset:256 nt
    buffer_load_dwordx4 v[76:79], v2, s[12:15], s32 offen offset:0 nt
    buffer_load_dwordx4 v[80:83], v2, s[12:15], s32 offen offset:128 nt
    buffer_load_dwordx4 v[84:87], v2, s[12:15], s32 offen offset:256 nt
    s_add_u32 s32, s74, 7
    s_mul_i32 s32, s32, 3072
    s_add_u32 s32, s32, s30
    buffer_load_dwordx4 v[88:91], v2, s[8:11], s32 offen offset:0 nt
    buffer_load_dwordx4 v[92:95], v2, s[8:11], s32 offen offset:128 nt
    buffer_load_dwordx4 v[96:99], v2, s[8:11], s32 offen offset:256 nt
    buffer_load_dwordx4 v[100:103], v2, s[12:15], s32 offen offset:0 nt
    buffer_load_dwordx4 v[104:107], v2, s[12:15], s32 offen offset:128 nt
    buffer_load_dwordx4 v[108:111], v2, s[12:15], s32 offen offset:256 nt
    s_barrier
    s_add_u32 s32, s74, 14
    s_mul_i32 s32, s32, 3072
    s_add_u32 s32, s32, s30
    buffer_load_dwordx4 v[112:115], v2, s[8:11], s32 offen offset:0 nt
    buffer_load_dwordx4 v[116:119], v2, s[8:11], s32 offen offset:128 nt
    buffer_load_dwordx4 v[120:123], v2, s[8:11], s32 offen offset:256 nt
    buffer_load_dwordx4 v[124:127], v2, s[12:15], s32 offen offset:0 nt
    buffer_load_dwordx4 v[128:131], v2, s[12:15], s32 offen offset:128 nt
    buffer_load_dwordx4 v[132:135], v2, s[12:15], s32 offen offset:256 nt
    s_add_u32 s32, s74, 21
    s_mul_i32 s32, s32, 3072
    s_add_u32 s32, s32, s30
    buffer_load_dwordx4 v[136:139], v2, s[8:11], s32 offen offset:0 nt
    buffer_load_dwordx4 v[140:143], v2, s[8:11], s32 offen offset:128 nt
    buffer_load_dwordx4 v[144:147], v2, s[8:11], s32 offen offset:256 nt
    buffer_load_dwordx4 v[148:151], v2, s[12:15], s32 offen offset:0 nt
    buffer_load_dwordx4 v[152:155], v2, s[12:15], s32 offen offset:128 nt
    buffer_load_dwordx4 v[156:159], v2, s[12:15], s32 offen offset:256 nt
    s_add_u32 s32, s74, 28
    s_mul_i32 s32, s32, 3072
    s_add_u32 s32, s32, s30
    buffer_load_dwordx4 v[160:163], v2, s[8:11], s32 offen offset:0 nt
    buffer_load_dwordx4 v[164:167], v2, s[8:11], s32 offen offset:128 nt
    buffer_load_dwordx4 v[168:171], v2, s[8:11], s32 offen offset:256 nt
    buffer_load_dwordx4 v[172:175], v2, s[12:15], s32 offen offset:0 nt
    buffer_load_dwordx4 v[176:179], v2, s[12:15], s32 offen offset:128 nt
    buffer_load_dwordx4 v[180:183], v2, s[12:15], s32 offen offset:256 nt
    s_add_u32 s32, s74, 35
    s_mul_i32 s32, s32, 3072
    s_add_u32 s32, s32, s30
    buffer_load_dwordx4 v[184:187], v2, s[8:11], s32 offen offset:0 nt
    buffer_load_dwordx4 v[188:191], v2, s[8:11], s32 offen offset:128 nt
    buffer_load_dwordx4 v[192:195], v2, s[8:11], s32 offen offset:256 nt
    buffer_load_dwordx4 v[196:199], v2, s[12:15], s32 offen offset:0 nt
    buffer_load_dwordx4 v[200:203], v2, s[12:15], s32 offen offset:128 nt
    buffer_load_dwordx4 v[204:207], v2, s[12:15], s32 offen offset:256 nt
    s_add_u32 s32, s74, 42
    s_mul_i32 s32, s32, 3072
    s_add_u32 s32, s32, s30
    buffer_load_dwordx4 v[208:211], v2, s[8:11], s32 offen offset:0 nt
    buffer_load_dwordx4 v[212:215], v2, s[8:11], s32 offen offset:128 nt
    buffer_load_dwordx4 v[216:219], v2, s[8:11], s32 offen offset:256 nt
    buffer_load_dwordx4 v[220:223], v2, s[12:15], s32 offen offset:0 nt
    buffer_load_dwordx4 v[224:227], v2, s[12:15], s32 offen offset:128 nt
    buffer_load_dwordx4 v[228:231], v2, s[12:15], s32 offen offset:256 nt
    s_add_u32 s32, s74, 49
    s_mul_i32 s32, s32, 3072
    s_add_u32 s32, s32, s30
    buffer_load_dwordx4 v[232:235], v2, s[8:11], s32 offen offset:0 nt
    buffer_load_dwordx4 v[236:239], v2, s[8:11], s32 offen offset:128 nt
    buffer_load_dwordx4 v[240:243], v2, s[8:11], s32 offen offset:256 nt
    buffer_load_dwordx4 v[244:247], v2, s[12:15], s32 offen offset:0 nt
    buffer_load_dwordx4 v[248:251], v2, s[12:15], s32 offen offset:128 nt
    buffer_load_dwordx4 v[252:255], v2, s[12:15], s32 offen offset:256 nt
    s_waitcnt vmcnt(48)
    s_branch L_pre_b3
L_hi_r0:
    s_add_u32 s32, s74, 0
    s_mul_i32 s32, s32, 3072
    s_add_u32 s32, s32, s30
    buffer_load_dwordx4 v[64:67], v2, s[8:11], s32 offen offset:0 nt
    buffer_load_dwordx4 v[68:71], v2, s[8:11], s32 offen offset:128 nt
    buffer_load_dwordx4 v[72:75], v2, s[8:11], s32 offen offset:256 nt
    buffer_load_dwordx4 v[76:79], v2, s[12:15], s32 offen offset:0 nt
    buffer_load_dwordx4 v[80:83], v2, s[12:15], s32 offen offset:128 nt
    buffer_load_dwordx4 v[84:87], v2, s[12:15], s32 offen offset:256 nt
    s_add_u32 s32, s74, 7
    s_mul_i32 s32, s32, 3072
    s_add_u32 s32, s32, s30
    buffer_load_dwordx4 v[88:91], v2, s[8:11], s32 offen offset:0 nt
    buffer_load_dwordx4 v[92:95], v2, s[8:11], s32 offen offset:128 nt
    buffer_load_dwordx4 v[96:99], v2, s[8:11], s32 offen offset:256 nt
    buffer_load_dwordx4 v[100:103], v2, s[12:15], s32 offen offset:0 nt
    buffer_load_dwordx4 v[104:107], v2, s[12:15], s32 offen offset:128 nt
    buffer_load_dwordx4 v[108:111], v2, s[12:15], s32 offen offset:256 nt
    s_add_u32 s32, s74, 14
    s_mul_i32 s32, s32, 3072
    s_add_u32 s32, s32, s30
    buffer_load_dwordx4 v[112:115], v2, s[8:11], s32 offen offset:0 nt
    buffer_load_dwordx4 v[116:119], v2, s[8:11], s32 offen offset:128 nt
    buffer_load_dwordx4 v[120:123], v2, s[8:11], s32 offen offset:256 nt
    buffer_load_dwordx4 v[124:127], v2, s[12:15], s32 offen offset:0 nt
    buffer_load_dwordx4 v[128:131], v2, s[12:15], s32 offen offset:128 nt
    buffer_load_dwordx4 v[132:135], v2, s[12:15], s32 offen offset:256 nt
    s_add_u32 s32, s74, 21
    s_mul_i32 s32, s32, 3072
    s_add_u32 s32, s32, s30
    buffer_load_dwordx4 v[136:139], v2, s[8:11], s32 offen offset:0 nt
    buffer_load_dwordx4 v[140:143], v2, s[8:11], s32 offen offset:128 nt
    buffer_load_dwordx4 v[144:147], v2, s[8:11], s32 offen offset:256 nt
    buffer_load_dwordx4 v[148:151], v2, s[12:15], s32 offen offset:0 nt
    buffer_load_dwordx4 v[152:155], v2, s[12:15], s32 offen offset:128 nt
    buffer_load_dwordx4 v[156:159], v2, s[12:15], s32 offen offset:256 nt
    s_add_u32 s32, s74, 28
    s_mul_i32 s32, s32, 3072
    s_add_u32 s32, s32, s30
    buffer_load_dwordx4 v[160:163], v2, s[8:11], s32 offen offset:0 nt
    buffer_load_dwordx4 v[164:167], v2, s[8:11], s32 offen offset:128 nt
    buffer_load_dwordx4 v[168:171], v2, s[8:11], s32 offen offset:256 nt
    buffer_load_dwordx4 v[172:175], v2, s[12:15], s32 offen offset:0 nt
    buffer_load_dwordx4 v[176:179], v2, s[12:15], s32 offen offset:128 nt
    buffer_load_dwordx4 v[180:183], v2, s[12:15], s32 offen offset:256 nt
    s_add_u32 s32, s74, 35
    s_mul_i32 s32, s32, 3072
    s_add_u32 s32, s32, s30
    buffer_load_dwordx4 v[184:187], v2, s[8:11], s32 offen offset:0 nt
    buffer_load_dwordx4 v[188:191], v2, s[8:11], s32 offen offset:128 nt
    buffer_load_dwordx4 v[192:195], v2, s[8:11], s32 offen offset:256 nt
    buffer_load_dwordx4 v[196:199], v2, s[12:15], s32 offen offset:0 nt
    buffer_load_dwordx4 v[200:203], v2, s[12:15], s32 offen offset:128 nt
    buffer_load_dwordx4 v[204:207], v2, s[12:15], s32 offen offset:256 nt
    s_add_u32 s32, s74, 42
    s_mul_i32 s32, s32, 3072
    s_add_u32 s32, s32, s30
    buffer_load_dwordx4 v[208:211], v2, s[8:11], s32 offen offset:0 nt
    buffer_load_dwordx4 v[212:215], v2, s[8:11], s32 offen offset:128 nt
    buffer_load_dwordx4 v[216:219], v2, s[8:11], s32 offen offset:256 nt
    buffer_load_dwordx4 v[220:223], v2, s[12:15], s32 offen offset:0 nt
    buffer_load_dwordx4 v[224:227], v2, s[12:15], s32 offen offset:128 nt
    buffer_load_dwordx4 v[228:231], v2, s[12:15], s32 offen offset:256 nt
    s_add_u32 s32, s74, 49
    s_mul_i32 s32, s32, 3072
    s_add_u32 s32, s32, s30
    buffer_load_dwordx4 v[232:235], v2, s[8:11], s32 offen offset:0 nt
    buffer_load_dwordx4 v[236:239], v2, s[8:11], s32 offen offset:128 nt
    buffer_load_dwordx4 v[240:243], v2, s[8:11], s32 offen offset:256 nt
    buffer_load_dwordx4 v[244:247], v2, s[12:15], s32 offen offset:0 nt
    buffer_load_dwordx4 v[248:251], v2, s[12:15], s32 offen offset:128 nt
    buffer_load_dwordx4 v[252:255], v2, s[12:15], s32 offen offset:256 nt
    s_waitcnt vmcnt(48)
    s_branch L_pre_b3
L_lo_waves:
    s_cmp_eq_u32 s3, 0
    s_cbranch_scc0 L_noprio
    s_cmp_eq_u32 s5, 0
    s_cbranch_scc0 L_noprio
    v_mov_b32 v18, 0
    s_mov_b64 exec, 1
    global_store_dword v3, v18, s[66:67] sc1
    s_mov_b64 exec, -1
L_noprio:
    s_cmp_eq_u32 s6, 1
    s_cbranch_scc0 L_lo_not1
    s_mov_b32 s92, s44
    s_mov_b32 s93, s45
    s_mov_b32 s94, 5120
    s_mov_b32 s95, 0x20000
    s_mul_i32 s33, s3, 1280
    v_lshlrev_b32 v62, 2, v1
    buffer_load_dword v16, v62, s[92:95], s33 offen offset:0
    buffer_load_dword v17, v62, s[92:95], s33 offen offset:256
    buffer_load_dword v18, v62, s[92:95], s33 offen offset:512
    buffer_load_dword v19, v62, s[92:95], s33 offen offset:768
    buffer_load_dword v20, v62, s[92:95], s33 offen offset:1024
    s_mov_b32 s20, s50
    s_mov_b32 s21, s51
    s_mov_b32 s22, 7864320
    s_mov_b32 s23, 0x20000
    s_cmp_eq_u32 s7, 1
    s_cselect_b32 s20, s56, s20
    s_cselect_b32 s21, s57, s21
    s_cselect_b32 s22, 1966080, s22
    s_cmp_eq_u32 s7, 2
    s_cselect_b32 s20, s58, s20
    s_cselect_b32 s21, s59, s21
    s_cselect_b32 s22, 1966080, s22
    s_cmp_eq_u32 s7, 3
    s_cselect_b32 s20, s60, s20
    s_cselect_b32 s21, s61, s21
    s_cselect_b32 s22, 1966080, s22
    s_mul_i32 s33, s3, 160
    v_lshrrev_b32 v54, 3, v1
    v_mul_lo_u32 v56, v54, s24
    v_and_b32 v55, 7, v1
    v_and_b32 v54, 2, v54
    v_xor_b32 v55, v55, v54
    v_xor_b32 v57, 4, v55
    v_lshlrev_b32 v55, 4, v55
    v_lshlrev_b32 v57, 4, v57
    v_add_u32 v54, v56, v55
    v_add_u32 v55, v56, v57
    s_mul_i32 s34, s33, s24
    s_add_u32 s34, s34, s25
    s_lshl_b32 s33, s33, 7
    s_add_u32 s33, s33, 0
    s_lshl_b32 s35, s24, 3
    s_mov_b32 m0, s33
    s_nop 0
    buffer_load_dwordx4 v54, s[20:23], s34 offen nt lds
    s_add_u32 s33, s33, 1024
    s_add_u32 s34, s34, s35
    s_mov_b32 m0, s33
    s_nop 0
    buffer_load_dwordx4 v55, s[20:23], s34 offen nt lds
    s_add_u32 s33, s33, 1024
    s_add_u32 s34, s34, s35
    s_mov_b32 m0, s33
    s_nop 0
    buffer_load_dwordx4 v54, s[20:23], s34 offen nt lds
    s_add_u32 s33, s33, 1024
    s_add_u32 s34, s34, s35
    s_mov_b32 m0, s33
    s_nop 0
    buffer_load_dwordx4 v55, s[20:23], s34 offen nt lds
    s_add_u32 s33, s33, 1024
    s_add_u32 s34, s34, s35
    s_mov_b32 m0, s33
    s_nop 0
    buffer_load_dwordx4 v54, s[20:23], s34 offen nt lds
    s_add_u32 s33, s33, 1024
    s_add_u32 s34, s34, s35
    s_mov_b32 m0, s33
    s_nop 0
    buffer_load_dwordx4 v55, s[20:23], s34 offen nt lds
    s_add_u32 s33, s33, 1024
    s_add_u32 s34, s34, s35
    s_mov_b32 m0, s33
    s_nop 0
    buffer_load_dwordx4 v54, s[20:23], s34 offen nt lds
    s_add_u32 s33, s33, 1024
    s_add_u32 s34, s34, s35
    s_mov_b32 m0, s33
    s_nop 0
    buffer_load_dwordx4 v55, s[20:23], s34 offen nt lds
    s_add_u32 s33, s33, 1024
    s_add_u32 s34, s34, s35
    s_mov_b32 m0, s33
    s_nop 0
    buffer_load_dwordx4 v54, s[20:23], s34 offen nt lds
    s_add_u32 s33, s33, 1024
    s_add_u32 s34, s34, s35
    s_mov_b32 m0, s33
    s_nop 0
    buffer_load_dwordx4 v55, s[20:23], s34 offen nt lds
    s_add_u32 s33, s33, 1024
    s_add_u32 s34, s34, s35
    s_mov_b32 m0, s33
    s_nop 0
    buffer_load_dwordx4 v54, s[20:23], s34 offen nt lds
    s_add_u32 s33, s33, 1024
    s_add_u32 s34, s34, s35
    s_mov_b32 m0, s33
    s_nop 0
    buffer_load_dwordx4 v55, s[20:23], s34 offen nt lds
    s_add_u32 s33, s33, 1024
    s_add_u32 s34, s34, s35
    s_mov_b32 m0, s33
    s_nop 0
    buffer_load_dwordx4 v54, s[20:23], s34 offen nt lds
    s_add_u32 s33, s33, 1024
    s_add_u32 s34, s34, s35
    s_mov_b32 m0, s33
    s_nop 0
    buffer_load_dwordx4 v55, s[20:23], s34 offen nt lds
    s_add_u32 s33, s33, 1024
    s_add_u32 s34, s34, s35
    s_mov_b32 m0, s33
    s_nop 0
    buffer_load_dwordx4 v54, s[20:23], s34 offen nt lds
    s_add_u32 s33, s33, 1024
    s_add_u32 s34, s34, s35
    s_mov_b32 m0, s33
    s_nop 0
    buffer_load_dwordx4 v55, s[20:23], s34 offen nt lds
    s_add_u32 s33, s33, 1024
    s_add_u32 s34, s34, s35
    s_mov_b32 m0, s33
    s_nop 0
    buffer_load_dwordx4 v54, s[20:23], s34 offen nt lds
    s_add_u32 s33, s33, 1024
    s_add_u32 s34, s34, s35
    s_mov_b32 m0, s33
    s_nop 0
    buffer_load_dwordx4 v55, s[20:23], s34 offen nt lds
    s_add_u32 s33, s33, 1024
    s_add_u32 s34, s34, s35
    s_mov_b32 m0, s33
    s_nop 0
    buffer_load_dwordx4 v54, s[20:23], s34 offen nt lds
    s_add_u32 s33, s33, 1024
    s_add_u32 s34, s34, s35
    s_mov_b32 m0, s33
    s_nop 0
    buffer_load_dwordx4 v55, s[20:23], s34 offen nt lds
    s_waitcnt vmcnt(20)
    v_lshlrev_b32 v24, 16, v16
    v_and_b32 v25, 0xffff0000, v16
    v_lshlrev_b32 v26, 16, v17
    v_and_b32 v27, 0xffff0000, v17
    v_lshlrev_b32 v28, 16, v18
    v_and_b32 v29, 0xffff0000, v18
    v_lshlrev_b32 v30, 16, v19
    v_and_b32 v31, 0xffff0000, v19
    v_lshlrev_b32 v32, 16, v20
    v_and_b32 v33, 0xffff0000, v20
    v_add_f32 v36, v24, v25
    v_add_f32 v36, v36, v26
    v_add_f32 v36, v36, v27
    v_add_f32 v36, v36, v28
    v_add_f32 v36, v36, v29
    v_add_f32 v36, v36, v30
    v_add_f32 v36, v36, v31
    v_add_f32 v36, v36, v32
    v_add_f32 v36, v36, v33
    s_nop 1
    v_add_f32_dpp v36, v36, v36 quad_perm:[1,0,3,2] row_mask:0xf bank_mask:0xf
    s_nop 1
    v_add_f32_dpp v36, v36, v36 quad_perm:[2,3,0,1] row_mask:0xf bank_mask:0xf
    s_nop 1
    v_add_f32_dpp v36, v36, v36 row_half_mirror row_mask:0xf bank_mask:0xf
    s_nop 1
    v_add_f32_dpp v36, v36, v36 row_mirror row_mask:0xf bank_mask:0xf
    v_mov_b32 v37, v36
    s_nop 1
    v_permlane16_swap_b32 v36, v37
    v_add_f32 v36, v36, v37
    v_mov_b32 v37, v36
    s_nop 1
    v_permlane32_swap_b32 v36, v37
    v_add_f32 v36, v36, v37
    v_mul_f32 v38, 0x3acccccd, v36
    v_sub_f32 v42, v24, v38
    v_mul_f32 v39, v42, v42
    v_sub_f32 v42, v25, v38
    v_fmac_f32 v39, v42, v42
    v_sub_f32 v42, v26, v38
    v_fmac_f32 v39, v42, v42
    v_sub_f32 v42, v27, v38
    v_fmac_f32 v39, v42, v42
    v_sub_f32 v42, v28, v38
    v_fmac_f32 v39, v42, v42
    v_sub_f32 v42, v29, v38
    v_fmac_f32 v39, v42, v42
    v_sub_f32 v42, v30, v38
    v_fmac_f32 v39, v42, v42
    v_sub_f32 v42, v31, v38
    v_fmac_f32 v39, v42, v42
    v_sub_f32 v42, v32, v38
    v_fmac_f32 v39, v42, v42
    v_sub_f32 v42, v33, v38
    v_fmac_f32 v39, v42, v42
    s_nop 1
    v_add_f32_dpp v39, v39, v39 quad_perm:[1,0,3,2] row_mask:0xf bank_mask:0xf
    s_nop 1
    v_add_f32_dpp v39, v39, v39 quad_perm:[2,3,0,1] row_mask:0xf bank_mask:0xf
    s_nop 1
    v_add_f32_dpp v39, v39, v39 row_half_mirror row_mask:0xf bank_mask:0xf
    s_nop 1
    v_add_f32_dpp v39, v39, v39 row_mirror row_mask:0xf bank_mask:0xf
    v_mov_b32 v37, v39
    s_nop 1
    v_permlane16_swap_b32 v39, v37
    v_add_f32 v39, v39, v37
    v_mov_b32 v37, v39
    s_nop 1
    v_permlane32_swap_b32 v39, v37
    v_add_f32 v39, v39, v37
    v_mul_f32 v39, 0x3acccccd, v39
    v_cvt_pk_bf16_f32 v38, v38, v38
    v_and_b32 v38, 0xffff0000, v38
    v_cvt_pk_bf16_f32 v39, v39, v39
    v_and_b32 v39, 0xffff0000, v39
    v_add_f32 v39, 0x3727c5ac, v39
    v_cvt_pk_bf16_f32 v39, v39, v39
    v_and_b32 v39, 0xffff0000, v39
    v_sqrt_f32 v40, v39
    s_nop 0
    v_cvt_pk_bf16_f32 v40, v40, v40
    v_and_b32 v40, 0xffff0000, v40
    v_rcp_f32 v41, v40
    s_mul_i32 s33, s3, 1312
    s_add_u32 s33, s33, 131072
    v_add_u32 v62, s33, v62
    v_sub_f32 v24, v24, v38
    v_sub_f32 v25, v25, v38
    v_cvt_pk_bf16_f32 v42, v24, v25
    v_lshlrev_b32 v24, 16, v42
    v_and_b32 v25, 0xffff0000, v42
    v_mul_f32 v43, v24, v41
    v_fma_f32 v44, -v43, v40, v24
    v_fma_f32 v24, v44, v41, v43
    v_mul_f32 v43, v25, v41
    v_fma_f32 v44, -v43, v40, v25
    v_fma_f32 v25, v44, v41, v43
    v_cvt_pk_bf16_f32 v42, v24, v25
    ds_write_b32 v62, v42 offset:0
    v_sub_f32 v26, v26, v38
    v_sub_f32 v27, v27, v38
    v_cvt_pk_bf16_f32 v42, v26, v27
    v_lshlrev_b32 v26, 16, v42
    v_and_b32 v27, 0xffff0000, v42
    v_mul_f32 v43, v26, v41
    v_fma_f32 v44, -v43, v40, v26
    v_fma_f32 v26, v44, v41, v43
    v_mul_f32 v43, v27, v41
    v_fma_f32 v44, -v43, v40, v27
    v_fma_f32 v27, v44, v41, v43
    v_cvt_pk_bf16_f32 v42, v26, v27
    ds_write_b32 v62, v42 offset:256
    v_sub_f32 v28, v28, v38
    v_sub_f32 v29, v29, v38
    v_cvt_pk_bf16_f32 v42, v28, v29
    v_lshlrev_b32 v28, 16, v42
    v_and_b32 v29, 0xffff0000, v42
    v_mul_f32 v43, v28, v41
    v_fma_f32 v44, -v43, v40, v28
    v_fma_f32 v28, v44, v41, v43
    v_mul_f32 v43, v29, v41
    v_fma_f32 v44, -v43, v40, v29
    v_fma_f32 v29, v44, v41, v43
    v_cvt_pk_bf16_f32 v42, v28, v29
    ds_write_b32 v62, v42 offset:512
    v_sub_f32 v30, v30, v38
    v_sub_f32 v31, v31, v38
    v_cvt_pk_bf16_f32 v42, v30, v31
    v_lshlrev_b32 v30, 16, v42
    v_and_b32 v31, 0xffff0000, v42
    v_mul_f32 v43, v30, v41
    v_fma_f32 v44, -v43, v40, v30
    v_fma_f32 v30, v44, v41, v43
    v_mul_f32 v43, v31, v41
    v_fma_f32 v44, -v43, v40, v31
    v_fma_f32 v31, v44, v41, v43
    v_cvt_pk_bf16_f32 v42, v30, v31
    ds_write_b32 v62, v42 offset:768
    v_sub_f32 v32, v32, v38
    v_sub_f32 v33, v33, v38
    v_cvt_pk_bf16_f32 v42, v32, v33
    v_lshlrev_b32 v32, 16, v42
    v_and_b32 v33, 0xffff0000, v42
    v_mul_f32 v43, v32, v41
    v_fma_f32 v44, -v43, v40, v32
    v_fma_f32 v32, v44, v41, v43
    v_mul_f32 v43, v33, v41
    v_fma_f32 v44, -v43, v40, v33
    v_fma_f32 v33, v44, v41, v43
    v_cvt_pk_bf16_f32 v42, v32, v33
    ds_write_b32 v62, v42 offset:1024
    v_lshrrev_b32 v24, 4, v1
    v_and_b32 v25, 15, v1
    v_lshrrev_b32 v26, 2, v25
    v_and_b32 v27, 3, v25
    v_lshlrev_b32 v16, 3, v24
    v_add_u32 v16, v16, v26
    v_lshlrev_b32 v16, 7, v16
    v_lshlrev_b32 v27, 3, v27
    v_add_u32 v16, v16, v27
    v_add_u32 v16, 0, v16
    v_lshrrev_b32 v26, 1, v26
    v_and_b32 v19, 1, v24
    v_lshlrev_b32 v19, 1, v19
    v_or_b32 v19, v19, v26
    v_and_b32 v26, 3, v1
    v_mul_u32_u24 v18, 1312, v26
    v_lshlrev_b32 v24, 4, v24
    v_add_u32 v18, v18, v24
    v_add_u32 v18, 131072, v18
    v_xor_b32 v27, s3, v19
    v_lshlrev_b32 v27, 5, v27
    v_add_u32 v16, v27, v16
    v_add_u32 v17, 0x10000, v16
    v_mov_b32 v20, 0
    v_mov_b32 v21, 0
    v_mov_b32 v22, 0
    v_mov_b32 v23, 0
    s_waitcnt vmcnt(0) lgkmcnt(0)
    s_barrier
    s_add_u32 s42, s68, 1
    s_not_b32 s43, s69
    ds_read_b64_tr_b16 v[64:65], v16 offset:0
    ds_read_b64_tr_b16 v[66:67], v16 offset:512
    ds_read_b128 v[68:71], v18 offset:0
    ds_read_b64_tr_b16 v[72:73], v16 offset:4096
    ds_read_b64_tr_b16 v[74:75], v16 offset:4608
    ds_read_b128 v[76:79], v18 offset:64
    ds_read_b64_tr_b16 v[80:81], v16 offset:8192
    ds_read_b64_tr_b16 v[82:83], v16 offset:8704
    ds_read_b128 v[84:87], v18 offset:128
    ds_read_b64_tr_b16 v[88:89], v16 offset:12288
    ds_read_b64_tr_b16 v[90:91], v16 offset:12800
    ds_read_b128 v[92:95], v18 offset:192
    ds_read_b64_tr_b16 v[96:97], v16 offset:16384
    ds_read_b64_tr_b16 v[98:99], v16 offset:16896
    ds_read_b128 v[100:103], v18 offset:256
    s_waitcnt lgkmcnt(12)
    v_mfma_f32_16x16x32_bf16 v[20:23], v[68:71], v[64:67], v[20:23]
    ds_read_b64_tr_b16 v[104:105], v16 offset:20480
    ds_read_b64_tr_b16 v[106:107], v16 offset:20992
    ds_read_b128 v[108:111], v18 offset:320
    s_waitcnt lgkmcnt(12)
    v_mfma_f32_16x16x32_bf16 v[20:23], v[76:79], v[72:75], v[20:23]
    ds_read_b64_tr_b16 v[112:113], v16 offset:24576
    ds_read_b64_tr_b16 v[114:115], v16 offset:25088
    ds_read_b128 v[116:119], v18 offset:384
    s_waitcnt lgkmcnt(12)
    v_mfma_f32_16x16x32_bf16 v[20:23], v[84:87], v[80:83], v[20:23]
    ds_read_b64_tr_b16 v[120:121], v16 offset:28672
    ds_read_b64_tr_b16 v[122:123], v16 offset:29184
    ds_read_b128 v[124:127], v18 offset:448
    s_waitcnt lgkmcnt(12)
    v_mfma_f32_16x16x32_bf16 v[20:23], v[92:95], v[88:91], v[20:23]
    ds_read_b64_tr_b16 v[128:129], v16 offset:32768
    ds_read_b64_tr_b16 v[130:131], v16 offset:33280
    ds_read_b128 v[132:135], v18 offset:512
    s_waitcnt lgkmcnt(12)
    v_mfma_f32_16x16x32_bf16 v[20:23], v[100:103], v[96:99], v[20:23]
    ds_read_b64_tr_b16 v[136:137], v16 offset:36864
    ds_read_b64_tr_b16 v[138:139], v16 offset:37376
    ds_read_b128 v[140:143], v18 offset:576
    s_waitcnt lgkmcnt(12)
    v_mfma_f32_16x16x32_bf16 v[20:23], v[108:111], v[104:107], v[20:23]
    ds_read_b64_tr_b16 v[64:65], v16 offset:40960
    ds_read_b64_tr_b16 v[66:67], v16 offset:41472
    ds_read_b128 v[68:71], v18 offset:640
    s_waitcnt lgkmcnt(12)
    v_mfma_f32_16x16x32_bf16 v[20:23], v[116:119], v[112:115], v[20:23]
    ds_read_b64_tr_b16 v[72:73], v16 offset:45056
    ds_read_b64_tr_b16 v[74:75], v16 offset:45568
    ds_read_b128 v[76:79], v18 offset:704
    s_waitcnt lgkmcnt(12)
    v_mfma_f32_16x16x32_bf16 v[20:23], v[124:127], v[120:123], v[20:23]
    ds_read_b64_tr_b16 v[80:81], v16 offset:49152
    ds_read_b64_tr_b16 v[82:83], v16 offset:49664
    ds_read_b128 v[84:87], v18 offset:768
    s_waitcnt lgkmcnt(12)
    v_mfma_f32_16x16x32_bf16 v[20:23], v[132:135], v[128:131], v[20:23]
    ds_read_b64_tr_b16 v[88:89], v16 offset:53248
    ds_read_b64_tr_b16 v[90:91], v16 offset:53760
    ds_read_b128 v[92:95], v18 offset:832
    s_waitcnt lgkmcnt(12)
    v_mfma_f32_16x16x32_bf16 v[20:23], v[140:143], v[136:139], v[20:23]
    ds_read_b64_tr_b16 v[96:97], v16 offset:57344
    ds_read_b64_tr_b16 v[98:99], v16 offset:57856
    ds_read_b128 v[100:103], v18 offset:896
    s_waitcnt lgkmcnt(12)
    v_mfma_f32_16x16x32_bf16 v[20:23], v[68:71], v[64:67], v[20:23]
    ds_read_b64_tr_b16 v[104:105], v16 offset:61440
    ds_read_b64_tr_b16 v[106:107], v16 offset:61952
    ds_read_b128 v[108:111], v18 offset:960
    s_waitcnt lgkmcnt(12)
    v_mfma_f32_16x16x32_bf16 v[20:23], v[76:79], v[72:75], v[20:23]
    ds_read_b64_tr_b16 v[112:113], v17 offset:0
    ds_read_b64_tr_b16 v[114:115], v17 offset:512
    ds_read_b128 v[116:119], v18 offset:1024
    s_waitcnt lgkmcnt(12)
    v_mfma_f32_16x16x32_bf16 v[20:23], v[84:87], v[80:83], v[20:23]
    ds_read_b64_tr_b16 v[120:121], v17 offset:4096
    ds_read_b64_tr_b16 v[122:123], v17 offset:4608
    ds_read_b128 v[124:127], v18 offset:1088
    s_waitcnt lgkmcnt(12)
    v_mfma_f32_16x16x32_bf16 v[20:23], v[92:95], v[88:91], v[20:23]
    ds_read_b64_tr_b16 v[128:129], v17 offset:8192
    ds_read_b64_tr_b16 v[130:131], v17 offset:8704
    ds_read_b128 v[132:135], v18 offset:1152
    s_waitcnt lgkmcnt(12)
    v_mfma_f32_16x16x32_bf16 v[20:23], v[100:103], v[96:99], v[20:23]
    ds_read_b64_tr_b16 v[136:137], v17 offset:12288
    ds_read_b64_tr_b16 v[138:139], v17 offset:12800
    ds_read_b128 v[140:143], v18 offset:1216
    s_waitcnt lgkmcnt(12)
    v_mfma_f32_16x16x32_bf16 v[20:23], v[108:111], v[104:107], v[20:23]
    s_waitcnt lgkmcnt(9)
    v_mfma_f32_16x16x32_bf16 v[20:23], v[116:119], v[112:115], v[20:23]
    s_waitcnt lgkmcnt(6)
    v_mfma_f32_16x16x32_bf16 v[20:23], v[124:127], v[120:123], v[20:23]
    s_waitcnt lgkmcnt(3)
    v_mfma_f32_16x16x32_bf16 v[20:23], v[132:135], v[128:131], v[20:23]
    s_waitcnt lgkmcnt(0)
    v_mfma_f32_16x16x32_bf16 v[20:23], v[140:143], v[136:139], v[20:23]
    v_mov_b32 v26, s42
    v_mov_b32 v27, s43
    v_lshlrev_b32 v28, 4, v1
    s_lshl_b32 s33, s3, 8
    s_add_u32 s33, s33, s26
    s_nop 2
    v_cvt_pk_bf16_f32 v24, v20, v21
    v_cvt_pk_bf16_f32 v25, v22, v23
    s_mov_b64 exec, 0xffff
    buffer_store_dwordx4 v[24:27], v28, s[16:19], s33 offen sc1
    s_mov_b64 exec, -1
    s_branch L_lo_pref
L_lo_not1:
    s_cmp_eq_u32 s6, 2
    s_cbranch_scc0 L_lo_pref0
    s_cmp_eq_u32 s3, 1
    s_cbranch_scc0 L_lo_pref0
    v_mov_b32 v20, -1
    v_lshlrev_b32 v16, 2, v1
    s_mov_b32 s33, s26
    buffer_store_dword v20, v16, s[16:19], s33 offen sc1
    s_add_u32 s33, s33, 2560
    buffer_store_dword v20, v16, s[16:19], s33 offen sc1
    s_add_u32 s33, s33, 2560
    buffer_store_dword v20, v16, s[16:19], s33 offen sc1
    s_add_u32 s33, s33, 2560
    buffer_store_dword v20, v16, s[16:19], s33 offen sc1
    s_mov_b32 s20, s50
    s_mov_b32 s21, s51
    s_mov_b32 s22, 7864320
    s_mov_b32 s23, 0x20000
    s_cmp_eq_u32 s7, 1
    s_cselect_b32 s20, s56, s20
    s_cselect_b32 s21, s57, s21
    s_cselect_b32 s22, 1966080, s22
    s_cmp_eq_u32 s7, 2
    s_cselect_b32 s20, s58, s20
    s_cselect_b32 s21, s59, s21
    s_cselect_b32 s22, 1966080, s22
    s_cmp_eq_u32 s7, 3
    s_cselect_b32 s20, s60, s20
    s_cselect_b32 s21, s61, s21
    s_cselect_b32 s22, 1966080, s22
    s_mov_b32 s33, 0
    v_lshrrev_b32 v54, 3, v1
    v_mul_lo_u32 v56, v54, s24
    v_and_b32 v55, 7, v1
    v_and_b32 v54, 2, v54
    v_xor_b32 v55, v55, v54
    v_xor_b32 v57, 4, v55
    v_lshlrev_b32 v55, 4, v55
    v_lshlrev_b32 v57, 4, v57
    v_add_u32 v54, v56, v55
    v_add_u32 v55, v56, v57
    s_mul_i32 s34, s33, s24
    s_add_u32 s34, s34, s25
    s_lshl_b32 s33, s33, 7
    s_add_u32 s33, s33, 32768
    s_lshl_b32 s35, s24, 3
    s_mov_b32 m0, s33
    s_nop 0
    buffer_load_dwordx4 v54, s[20:23], s34 offen nt lds
    s_add_u32 s33, s33, 1024
    s_add_u32 s34, s34, s35
    s_mov_b32 m0, s33
    s_nop 0
    buffer_load_dwordx4 v55, s[20:23], s34 offen nt lds
    s_add_u32 s33, s33, 1024
    s_add_u32 s34, s34, s35
    s_mov_b32 m0, s33
    s_nop 0
    buffer_load_dwordx4 v54, s[20:23], s34 offen nt lds
    s_add_u32 s33, s33, 1024
    s_add_u32 s34, s34, s35
    s_mov_b32 m0, s33
    s_nop 0
    buffer_load_dwordx4 v55, s[20:23], s34 offen nt lds
    s_add_u32 s33, s33, 1024
    s_add_u32 s34, s34, s35
    s_mov_b32 m0, s33
    s_nop 0
    buffer_load_dwordx4 v54, s[20:23], s34 offen nt lds
    s_add_u32 s33, s33, 1024
    s_add_u32 s34, s34, s35
    s_mov_b32 m0, s33
    s_nop 0
    buffer_load_dwordx4 v55, s[20:23], s34 offen nt lds
    s_add_u32 s33, s33, 1024
    s_add_u32 s34, s34, s35
    s_mov_b32 m0, s33
    s_nop 0
    buffer_load_dwordx4 v54, s[20:23], s34 offen nt lds
    s_add_u32 s33, s33, 1024
    s_add_u32 s34, s34, s35
    s_mov_b32 m0, s33
    s_nop 0
    buffer_load_dwordx4 v55, s[20:23], s34 offen nt lds
    s_add_u32 s33, s33, 1024
    s_add_u32 s34, s34, s35
    s_mov_b32 m0, s33
    s_nop 0
    buffer_load_dwordx4 v54, s[20:23], s34 offen nt lds
    s_add_u32 s33, s33, 1024
    s_add_u32 s34, s34, s35
    s_mov_b32 m0, s33
    s_nop 0
    buffer_load_dwordx4 v55, s[20:23], s34 offen nt lds
    s_add_u32 s33, s33, 1024
    s_add_u32 s34, s34, s35
    s_mov_b32 m0, s33
    s_nop 0
    buffer_load_dwordx4 v54, s[20:23], s34 offen nt lds
    s_add_u32 s33, s33, 1024
    s_add_u32 s34, s34, s35
    s_mov_b32 m0, s33
    s_nop 0
    buffer_load_dwordx4 v55, s[20:23], s34 offen nt lds
    s_add_u32 s33, s33, 1024
    s_add_u32 s34, s34, s35
    s_mov_b32 m0, s33
    s_nop 0
    buffer_load_dwordx4 v54, s[20:23], s34 offen nt lds
    s_add_u32 s33, s33, 1024
    s_add_u32 s34, s34, s35
    s_mov_b32 m0, s33
    s_nop 0
    buffer_load_dwordx4 v55, s[20:23], s34 offen nt lds
    s_add_u32 s33, s33, 1024
    s_add_u32 s34, s34, s35
    s_mov_b32 m0, s33
    s_nop 0
    buffer_load_dwordx4 v54, s[20:23], s34 offen nt lds
    s_add_u32 s33, s33, 1024
    s_add_u32 s34, s34, s35
    s_mov_b32 m0, s33
    s_nop 0
    buffer_load_dwordx4 v55, s[20:23], s34 offen nt lds
    s_add_u32 s33, s33, 1024
    s_add_u32 s34, s34, s35
    s_mov_b32 m0, s33
    s_nop 0
    buffer_load_dwordx4 v54, s[20:23], s34 offen nt lds
    s_add_u32 s33, s33, 1024
    s_add_u32 s34, s34, s35
    s_mov_b32 m0, s33
    s_nop 0
    buffer_load_dwordx4 v55, s[20:23], s34 offen nt lds
    s_add_u32 s33, s33, 1024
    s_add_u32 s34, s34, s35
    s_mov_b32 m0, s33
    s_nop 0
    buffer_load_dwordx4 v54, s[20:23], s34 offen nt lds
    s_add_u32 s33, s33, 1024
    s_add_u32 s34, s34, s35
    s_mov_b32 m0, s33
    s_nop 0
    buffer_load_dwordx4 v55, s[20:23], s34 offen nt lds
    s_add_u32 s33, s33, 1024
    s_add_u32 s34, s34, s35
    s_mov_b32 m0, s33
    s_nop 0
    buffer_load_dwordx4 v54, s[20:23], s34 offen nt lds
    s_add_u32 s33, s33, 1024
    s_add_u32 s34, s34, s35
    s_mov_b32 m0, s33
    s_nop 0
    buffer_load_dwordx4 v55, s[20:23], s34 offen nt lds
    s_add_u32 s33, s33, 1024
    s_add_u32 s34, s34, s35
    s_mov_b32 m0, s33
    s_nop 0
    buffer_load_dwordx4 v54, s[20:23], s34 offen nt lds
    s_add_u32 s33, s33, 1024
    s_add_u32 s34, s34, s35
    s_mov_b32 m0, s33
    s_nop 0
    buffer_load_dwordx4 v55, s[20:23], s34 offen nt lds
    s_add_u32 s33, s33, 1024
    s_add_u32 s34, s34, s35
    s_mov_b32 m0, s33
    s_nop 0
    buffer_load_dwordx4 v54, s[20:23], s34 offen nt lds
    s_add_u32 s33, s33, 1024
    s_add_u32 s34, s34, s35
    s_mov_b32 m0, s33
    s_nop 0
    buffer_load_dwordx4 v55, s[20:23], s34 offen nt lds
    s_add_u32 s33, s33, 1024
    s_add_u32 s34, s34, s35
    s_mov_b32 m0, s33
    s_nop 0
    buffer_load_dwordx4 v54, s[20:23], s34 offen nt lds
    s_add_u32 s33, s33, 1024
    s_add_u32 s34, s34, s35
    s_mov_b32 m0, s33
    s_nop 0
    buffer_load_dwordx4 v55, s[20:23], s34 offen nt lds
    s_add_u32 s33, s33, 1024
    s_add_u32 s34, s34, s35
    s_mov_b32 m0, s33
    s_nop 0
    buffer_load_dwordx4 v54, s[20:23], s34 offen nt lds
    s_add_u32 s33, s33, 1024
    s_add_u32 s34, s34, s35
    s_mov_b32 m0, s33
    s_nop 0
    buffer_load_dwordx4 v55, s[20:23], s34 offen nt lds
    s_add_u32 s33, s33, 1024
    s_add_u32 s34, s34, s35
    s_mov_b32 m0, s33
    s_nop 0
    buffer_load_dwordx4 v54, s[20:23], s34 offen nt lds
    s_add_u32 s33, s33, 1024
    s_add_u32 s34, s34, s35
    s_mov_b32 m0, s33
    s_nop 0
    buffer_load_dwordx4 v55, s[20:23], s34 offen nt lds
    s_add_u32 s33, s33, 1024
    s_add_u32 s34, s34, s35
    s_mov_b32 m0, s33
    s_nop 0
    buffer_load_dwordx4 v54, s[20:23], s34 offen nt lds
    s_add_u32 s33, s33, 1024
    s_add_u32 s34, s34, s35
    s_mov_b32 m0, s33
    s_nop 0
    buffer_load_dwordx4 v55, s[20:23], s34 offen nt lds
    s_add_u32 s33, s33, 1024
    s_add_u32 s34, s34, s35
    s_mov_b32 m0, s33
    s_nop 0
    buffer_load_dwordx4 v54, s[20:23], s34 offen nt lds
    s_add_u32 s33, s33, 1024
    s_add_u32 s34, s34, s35
    s_mov_b32 m0, s33
    s_nop 0
    buffer_load_dwordx4 v55, s[20:23], s34 offen nt lds
    s_add_u32 s33, s33, 1024
    s_add_u32 s34, s34, s35
    s_mov_b32 m0, s33
    s_nop 0
    buffer_load_dwordx4 v54, s[20:23], s34 offen nt lds
    s_add_u32 s33, s33, 1024
    s_add_u32 s34, s34, s35
    s_mov_b32 m0, s33
    s_nop 0
    buffer_load_dwordx4 v55, s[20:23], s34 offen nt lds
    s_add_u32 s33, s33, 1024
    s_add_u32 s34, s34, s35
    s_mov_b32 m0, s33
    s_nop 0
    buffer_load_dwordx4 v54, s[20:23], s34 offen nt lds
    s_add_u32 s33, s33, 1024
    s_add_u32 s34, s34, s35
    s_mov_b32 m0, s33
    s_nop 0
    buffer_load_dwordx4 v55, s[20:23], s34 offen nt lds
    s_add_u32 s33, s33, 1024
    s_add_u32 s34, s34, s35
    s_mov_b32 m0, s33
    s_nop 0
    buffer_load_dwordx4 v54, s[20:23], s34 offen nt lds
    s_add_u32 s33, s33, 1024
    s_add_u32 s34, s34, s35
    s_mov_b32 m0, s33
    s_nop 0
    buffer_load_dwordx4 v55, s[20:23], s34 offen nt lds
    s_add_u32 s33, s33, 1024
    s_add_u32 s34, s34, s35
    s_mov_b32 m0, s33
    s_nop 0
    buffer_load_dwordx4 v54, s[20:23], s34 offen nt lds
    s_add_u32 s33, s33, 1024
    s_add_u32 s34, s34, s35
    s_mov_b32 m0, s33
    s_nop 0
    buffer_load_dwordx4 v55, s[20:23], s34 offen nt lds
    s_add_u32 s33, s33, 1024
    s_add_u32 s34, s34, s35
    s_mov_b32 m0, s33
    s_nop 0
    buffer_load_dwordx4 v54, s[20:23], s34 offen nt lds
    s_add_u32 s33, s33, 1024
    s_add_u32 s34, s34, s35
    s_mov_b32 m0, s33
    s_nop 0
    buffer_load_dwordx4 v55, s[20:23], s34 offen nt lds
    s_add_u32 s33, s33, 1024
    s_add_u32 s34, s34, s35
    s_mov_b32 m0, s33
    s_nop 0
    buffer_load_dwordx4 v54, s[20:23], s34 offen nt lds
    s_add_u32 s33, s33, 1024
    s_add_u32 s34, s34, s35
    s_mov_b32 m0, s33
    s_nop 0
    buffer_load_dwordx4 v55, s[20:23], s34 offen nt lds
    s_add_u32 s33, s33, 1024
    s_add_u32 s34, s34, s35
    s_mov_b32 m0, s33
    s_nop 0
    buffer_load_dwordx4 v54, s[20:23], s34 offen nt lds
    s_add_u32 s33, s33, 1024
    s_add_u32 s34, s34, s35
    s_mov_b32 m0, s33
    s_nop 0
    buffer_load_dwordx4 v55, s[20:23], s34 offen nt lds
    s_add_u32 s33, s33, 1024
    s_add_u32 s34, s34, s35
    s_mov_b32 m0, s33
    s_nop 0
    buffer_load_dwordx4 v54, s[20:23], s34 offen nt lds
    s_add_u32 s33, s33, 1024
    s_add_u32 s34, s34, s35
    s_mov_b32 m0, s33
    s_nop 0
    buffer_load_dwordx4 v55, s[20:23], s34 offen nt lds
    s_add_u32 s33, s33, 1024
    s_add_u32 s34, s34, s35
    s_mov_b32 m0, s33
    s_nop 0
    buffer_load_dwordx4 v54, s[20:23], s34 offen nt lds
    s_add_u32 s33, s33, 1024
    s_add_u32 s34, s34, s35
    s_mov_b32 m0, s33
    s_nop 0
    buffer_load_dwordx4 v55, s[20:23], s34 offen nt lds
    s_add_u32 s33, s33, 1024
    s_add_u32 s34, s34, s35
    s_mov_b32 m0, s33
    s_nop 0
    buffer_load_dwordx4 v54, s[20:23], s34 offen nt lds
    s_add_u32 s33, s33, 1024
    s_add_u32 s34, s34, s35
    s_mov_b32 m0, s33
    s_nop 0
    buffer_load_dwordx4 v55, s[20:23], s34 offen nt lds
    s_add_u32 s33, s33, 1024
    s_add_u32 s34, s34, s35
    s_mov_b32 m0, s33
    s_nop 0
    buffer_load_dwordx4 v54, s[20:23], s34 offen nt lds
    s_add_u32 s33, s33, 1024
    s_add_u32 s34, s34, s35
    s_mov_b32 m0, s33
    s_nop 0
    buffer_load_dwordx4 v55, s[20:23], s34 offen nt lds
    s_add_u32 s33, s33, 1024
    s_add_u32 s34, s34, s35
    s_mov_b32 m0, s33
    s_nop 0
    buffer_load_dwordx4 v54, s[20:23], s34 offen nt lds
    s_add_u32 s33, s33, 1024
    s_add_u32 s34, s34, s35
    s_mov_b32 m0, s33
    s_nop 0
    buffer_load_dwordx4 v55, s[20:23], s34 offen nt lds
    s_add_u32 s33, s33, 1024
    s_add_u32 s34, s34, s35
    s_mov_b32 m0, s33
    s_nop 0
    buffer_load_dwordx4 v54, s[20:23], s34 offen nt lds
    s_add_u32 s33, s33, 1024
    s_add_u32 s34, s34, s35
    s_mov_b32 m0, s33
    s_nop 0
    buffer_load_dwordx4 v55, s[20:23], s34 offen nt lds
    s_add_u32 s33, s33, 1024
    s_add_u32 s34, s34, s35
    s_mov_b32 m0, s33
    s_nop 0
    buffer_load_dwordx4 v54, s[20:23], s34 offen nt lds
    s_add_u32 s33, s33, 1024
    s_add_u32 s34, s34, s35
    s_mov_b32 m0, s33
    s_nop 0
    buffer_load_dwordx4 v55, s[20:23], s34 offen nt lds
    s_waitcnt vmcnt(63)
    s_branch L_pre_b3
L_lo_pref0:
L_lo_pref:
    s_add_u32 s32, s74, 0
    s_mul_i32 s32, s32, 3072
    s_add_u32 s32, s32, s30
    buffer_load_dwordx4 v[64:67], v2, s[8:11], s32 offen offset:0 nt
    buffer_load_dwordx4 v[68:71], v2, s[8:11], s32 offen offset:128 nt
    buffer_load_dwordx4 v[72:75], v2, s[8:11], s32 offen offset:256 nt
    buffer_load_dwordx4 v[76:79], v2, s[12:15], s32 offen offset:0 nt
    buffer_load_dwordx4 v[80:83], v2, s[12:15], s32 offen offset:128 nt
    buffer_load_dwordx4 v[84:87], v2, s[12:15], s32 offen offset:256 nt
    s_add_u32 s32, s74, 7
    s_mul_i32 s32, s32, 3072
    s_add_u32 s32, s32, s30
    buffer_load_dwordx4 v[88:91], v2, s[8:11], s32 offen offset:0 nt
    buffer_load_dwordx4 v[92:95], v2, s[8:11], s32 offen offset:128 nt
    buffer_load_dwordx4 v[96:99], v2, s[8:11], s32 offen offset:256 nt
    buffer_load_dwordx4 v[100:103], v2, s[12:15], s32 offen offset:0 nt
    buffer_load_dwordx4 v[104:107], v2, s[12:15], s32 offen offset:128 nt
    buffer_load_dwordx4 v[108:111], v2, s[12:15], s32 offen offset:256 nt
    s_add_u32 s32, s74, 14
    s_mul_i32 s32, s32, 3072
    s_add_u32 s32, s32, s30
    buffer_load_dwordx4 v[112:115], v2, s[8:11], s32 offen offset:0 nt
    buffer_load_dwordx4 v[116:119], v2, s[8:11], s32 offen offset:128 nt
    buffer_load_dwordx4 v[120:123], v2, s[8:11], s32 offen offset:256 nt
    buffer_load_dwordx4 v[124:127], v2, s[12:15], s32 offen offset:0 nt
    buffer_load_dwordx4 v[128:131], v2, s[12:15], s32 offen offset:128 nt
    buffer_load_dwordx4 v[132:135], v2, s[12:15], s32 offen offset:256 nt
    s_add_u32 s32, s74, 21
    s_mul_i32 s32, s32, 3072
    s_add_u32 s32, s32, s30
    buffer_load_dwordx4 v[136:139], v2, s[8:11], s32 offen offset:0 nt
    buffer_load_dwordx4 v[140:143], v2, s[8:11], s32 offen offset:128 nt
    buffer_load_dwordx4 v[144:147], v2, s[8:11], s32 offen offset:256 nt
    buffer_load_dwordx4 v[148:151], v2, s[12:15], s32 offen offset:0 nt
    buffer_load_dwordx4 v[152:155], v2, s[12:15], s32 offen offset:128 nt
    buffer_load_dwordx4 v[156:159], v2, s[12:15], s32 offen offset:256 nt
    s_add_u32 s32, s74, 28
    s_mul_i32 s32, s32, 3072
    s_add_u32 s32, s32, s30
    buffer_load_dwordx4 v[160:163], v2, s[8:11], s32 offen offset:0 nt
    buffer_load_dwordx4 v[164:167], v2, s[8:11], s32 offen offset:128 nt
    buffer_load_dwordx4 v[168:171], v2, s[8:11], s32 offen offset:256 nt
    buffer_load_dwordx4 v[172:175], v2, s[12:15], s32 offen offset:0 nt
    buffer_load_dwordx4 v[176:179], v2, s[12:15], s32 offen offset:128 nt
    buffer_load_dwordx4 v[180:183], v2, s[12:15], s32 offen offset:256 nt
    s_add_u32 s32, s74, 35
    s_mul_i32 s32, s32, 3072
    s_add_u32 s32, s32, s30
    buffer_load_dwordx4 v[184:187], v2, s[8:11], s32 offen offset:0 nt
    buffer_load_dwordx4 v[188:191], v2, s[8:11], s32 offen offset:128 nt
    buffer_load_dwordx4 v[192:195], v2, s[8:11], s32 offen offset:256 nt
    buffer_load_dwordx4 v[196:199], v2, s[12:15], s32 offen offset:0 nt
    buffer_load_dwordx4 v[200:203], v2, s[12:15], s32 offen offset:128 nt
    buffer_load_dwordx4 v[204:207], v2, s[12:15], s32 offen offset:256 nt
    s_add_u32 s32, s74, 42
    s_mul_i32 s32, s32, 3072
    s_add_u32 s32, s32, s30
    buffer_load_dwordx4 v[208:211], v2, s[8:11], s32 offen offset:0 nt
    buffer_load_dwordx4 v[212:215], v2, s[8:11], s32 offen offset:128 nt
    buffer_load_dwordx4 v[216:219], v2, s[8:11], s32 offen offset:256 nt
    buffer_load_dwordx4 v[220:223], v2, s[12:15], s32 offen offset:0 nt
    buffer_load_dwordx4 v[224:227], v2, s[12:15], s32 offen offset:128 nt
    buffer_load_dwordx4 v[228:231], v2, s[12:15], s32 offen offset:256 nt
    s_add_u32 s32, s74, 49
    s_mul_i32 s32, s32, 3072
    s_add_u32 s32, s32, s30
    buffer_load_dwordx4 v[232:235], v2, s[8:11], s32 offen offset:0 nt
    buffer_load_dwordx4 v[236:239], v2, s[8:11], s32 offen offset:128 nt
    buffer_load_dwordx4 v[240:243], v2, s[8:11], s32 offen offset:256 nt
    buffer_load_dwordx4 v[244:247], v2, s[12:15], s32 offen offset:0 nt
    buffer_load_dwordx4 v[248:251], v2, s[12:15], s32 offen offset:128 nt
    buffer_load_dwordx4 v[252:255], v2, s[12:15], s32 offen offset:256 nt
    s_branch L_pre_b3
L_w0_q:
    s_waitcnt lgkmcnt(0)
    s_add_u32 s42, s68, 1
    s_not_b32 s43, s69
    v_lshlrev_b32 v16, 4, v1
    s_mul_i32 s33, s4, 3072
    s_add_u32 s33, s33, 32768
    s_mov_b32 s36, 0
L_qpoll:
    buffer_load_dwordx4 v[20:23], v16, s[16:19], s33 offen offset:0 sc1
    buffer_load_dwordx4 v[24:27], v16, s[16:19], s33 offen offset:1024 sc1
    buffer_load_dwordx4 v[28:31], v16, s[16:19], s33 offen offset:2048 sc1
    s_waitcnt vmcnt(0)
    v_xor_b32 v32, s42, v22
    v_xor_b32 v33, s43, v23
    v_or_b32 v32, v32, v33
    v_xor_b32 v33, s42, v26
    v_or_b32 v32, v32, v33
    v_xor_b32 v33, s43, v27
    v_or_b32 v32, v32, v33
    v_xor_b32 v33, s42, v30
    v_or_b32 v32, v32, v33
    v_xor_b32 v33, s43, v31
    v_or_b32 v32, v32, v33
    v_cmp_ne_u32 vcc, 0, v32
    s_cbranch_vccz L_qpoll_ok
    s_add_u32 s36, s36, 1
    s_cmp_lt_u32 s36, 40000
    s_cbranch_scc0 L_qpoll_ok
    s_sleep 1
    s_branch L_qpoll
L_qpoll_ok:
    v_lshlrev_b32 v17, 1, v1
    v_add_u32 v17, 136320, v17
    ds_write_b16 v17, v20 offset:0
    ds_write_b16_d16_hi v17, v20 offset:384
    ds_write_b16 v17, v21 offset:768
    ds_write_b16_d16_hi v17, v21 offset:1152
    ds_write_b16 v17, v24 offset:128
    ds_write_b16_d16_hi v17, v24 offset:512
    ds_write_b16 v17, v25 offset:896
    ds_write_b16_d16_hi v17, v25 offset:1280
    ds_write_b16 v17, v28 offset:256
    ds_write_b16_d16_hi v17, v28 offset:640
    ds_write_b16 v17, v29 offset:1024
    ds_write_b16_d16_hi v17, v29 offset:1408
    s_waitcnt lgkmcnt(0)
    s_barrier
    s_setprio 0
    s_waitcnt vmcnt(0)
    s_branch L_post_b3
L_pre_b3:
    s_barrier
L_post_b3:
    s_cmp_eq_u32 s3, 4
    s_cbranch_scc0 L_noclr
    v_mov_b32 v62, 192
    s_mov_b64 exec, 1
    global_atomic_add v62, v4, s[64:65]
    s_mov_b64 exec, -1
L_noclr:
    s_cmp_eq_u32 s6, 2
    s_cbranch_scc0 L_noffn2
    s_cmp_eq_u32 s3, 1
    s_cbranch_scc0 L_noffn2
    s_waitcnt vmcnt(0) lgkmcnt(0)
    s_add_u32 s42, s68, 1
    s_not_b32 s43, s69
    v_lshlrev_b32 v16, 4, v1
    s_lshl_b32 s33, s29, 13
    s_add_u32 s33, s33, 131072
    s_mov_b32 s36, 0
L_f1poll:
    s_mov_b32 s34, s33
    buffer_load_dwordx4 v[64:67], v16, s[16:19], s34 offen sc1
    s_add_u32 s35, s34, 24576
    buffer_load_dwordx4 v[96:99], v16, s[16:19], s35 offen sc1
    s_add_u32 s34, s34, 1024
    buffer_load_dwordx4 v[68:71], v16, s[16:19], s34 offen sc1
    s_add_u32 s35, s34, 24576
    buffer_load_dwordx4 v[100:103], v16, s[16:19], s35 offen sc1
    s_add_u32 s34, s34, 1024
    buffer_load_dwordx4 v[72:75], v16, s[16:19], s34 offen sc1
    s_add_u32 s35, s34, 24576
    buffer_load_dwordx4 v[104:107], v16, s[16:19], s35 offen sc1
    s_add_u32 s34, s34, 1024
    buffer_load_dwordx4 v[76:79], v16, s[16:19], s34 offen sc1
    s_add_u32 s35, s34, 24576
    buffer_load_dwordx4 v[108:111], v16, s[16:19], s35 offen sc1
    s_add_u32 s34, s34, 1024
    buffer_load_dwordx4 v[80:83], v16, s[16:19], s34 offen sc1
    s_add_u32 s35, s34, 24576
    buffer_load_dwordx4 v[112:115], v16, s[16:19], s35 offen sc1
    s_add_u32 s34, s34, 1024
    buffer_load_dwordx4 v[84:87], v16, s[16:19], s34 offen sc1
    s_add_u32 s35, s34, 24576
    buffer_load_dwordx4 v[116:119], v16, s[16:19], s35 offen sc1
    s_add_u32 s34, s34, 1024
    buffer_load_dwordx4 v[88:91], v16, s[16:19], s34 offen sc1
    s_add_u32 s35, s34, 24576
    buffer_load_dwordx4 v[120:123], v16, s[16:19], s35 offen sc1
    s_add_u32 s34, s34, 1024
    buffer_load_dwordx4 v[92:95], v16, s[16:19], s34 offen sc1
    s_add_u32 s35, s34, 24576
    buffer_load_dwordx4 v[124:127], v16, s[16:19], s35 offen sc1
    s_waitcnt vmcnt(0)
    v_mov_b32 v32, 0
    v_xor_b32 v33, s42, v66
    v_or_b32 v32, v32, v33
    v_xor_b32 v33, s43, v67
    v_or_b32 v32, v32, v33
    v_xor_b32 v33, s42, v70
    v_or_b32 v32, v32, v33
    v_xor_b32 v33, s43, v71
    v_or_b32 v32, v32, v33
    v_xor_b32 v33, s42, v74
    v_or_b32 v32, v32, v33
    v_xor_b32 v33, s43, v75
    v_or_b32 v32, v32, v33
    v_xor_b32 v33, s42, v78
    v_or_b32 v32, v32, v33
    v_xor_b32 v33, s43, v79
    v_or_b32 v32, v32, v33
    v_xor_b32 v33, s42, v82
    v_or_b32 v32, v32, v33
    v_xor_b32 v33, s43, v83
    v_or_b32 v32, v32, v33
    v_xor_b32 v33, s42, v86
    v_or_b32 v32, v32, v33
    v_xor_b32 v33, s43, v87
    v_or_b32 v32, v32, v33
    v_xor_b32 v33, s42, v90
    v_or_b32 v32, v32, v33
    v_xor_b32 v33, s43, v91
    v_or_b32 v32, v32, v33
    v_xor_b32 v33, s42, v94
    v_or_b32 v32, v32, v33
    v_xor_b32 v33, s43, v95
    v_or_b32 v32, v32, v33
    v_xor_b32 v33, s42, v98
    v_or_b32 v32, v32, v33
    v_xor_b32 v33, s43, v99
    v_or_b32 v32, v32, v33
    v_xor_b32 v33, s42, v102
    v_or_b32 v32, v32, v33
    v_xor_b32 v33, s43, v103
    v_or_b32 v32, v32, v33
    v_xor_b32 v33, s42, v106
    v_or_b32 v32, v32, v33
    v_xor_b32 v33, s43, v107
    v_or_b32 v32, v32, v33
    v_xor_b32 v33, s42, v110
    v_or_b32 v32, v32, v33
    v_xor_b32 v33, s43, v111
    v_or_b32 v32, v32, v33
    v_xor_b32 v33, s42, v114
    v_or_b32 v32, v32, v33
    v_xor_b32 v33, s43, v115
    v_or_b32 v32, v32, v33
    v_xor_b32 v33, s42, v118
    v_or_b32 v32, v32, v33
    v_xor_b32 v33, s43, v119
    v_or_b32 v32, v32, v33
    v_xor_b32 v33, s42, v122
    v_or_b32 v32, v32, v33
    v_xor_b32 v33, s43, v123
    v_or_b32 v32, v32, v33
    v_xor_b32 v33, s42, v126
    v_or_b32 v32, v32, v33
    v_xor_b32 v33, s43, v127
    v_or_b32 v32, v32, v33
    v_cmp_ne_u32 vcc, 0, v32
    s_cbranch_vccz L_f1poll_ok
    s_add_u32 s36, s36, 1
    s_cmp_lt_u32 s36, 40000
    s_cbranch_scc0 L_f1poll_ok
    s_sleep 16
    s_branch L_f1poll
L_f1poll_ok:
    s_mov_b32 s40, 0x3d372713
    s_mov_b32 s41, 0xc0135761
    v_lshlrev_b32 v17, 1, v1
    v_add_u32 v17, 131072, v17
    v_lshlrev_b32 v20, 16, v64
    v_lshlrev_b32 v21, 16, v96
    v_mul_f32 v36, v20, v20
    v_mul_f32 v36, v36, v20
    v_fma_f32 v36, v36, s40, v20
    v_mul_f32 v36, s41, v36
    v_exp_f32 v36, v36
    s_nop 0
    v_add_f32 v36, 1.0, v36
    v_rcp_f32 v37, v36
    s_nop 0
    v_mul_f32 v40, v20, v37
    v_fma_f32 v39, -v40, v36, v20
    v_fma_f32 v38, v39, v37, v40
    v_cmp_o_f32 vcc, v38, v38
    s_nop 1
    v_cndmask_b32 v38, v40, v38, vcc
    v_cvt_pk_bf16_f32 v38, v38, v38
    v_and_b32 v38, 0xffff0000, v38
    v_mul_f32 v38, v38, v21
    v_cvt_pk_bf16_f32 v38, v38, v38
    ds_write_b16 v17, v38 offset:0
    v_and_b32 v20, 0xffff0000, v64
    v_and_b32 v21, 0xffff0000, v96
    v_mul_f32 v36, v20, v20
    v_mul_f32 v36, v36, v20
    v_fma_f32 v36, v36, s40, v20
    v_mul_f32 v36, s41, v36
    v_exp_f32 v36, v36
    s_nop 0
    v_add_f32 v36, 1.0, v36
    v_rcp_f32 v37, v36
    s_nop 0
    v_mul_f32 v40, v20, v37
    v_fma_f32 v39, -v40, v36, v20
    v_fma_f32 v38, v39, v37, v40
    v_cmp_o_f32 vcc, v38, v38
    s_nop 1
    v_cndmask_b32 v38, v40, v38, vcc
    v_cvt_pk_bf16_f32 v38, v38, v38
    v_and_b32 v38, 0xffff0000, v38
    v_mul_f32 v38, v38, v21
    v_cvt_pk_bf16_f32 v38, v38, v38
    ds_write_b16 v17, v38 offset:1056
    v_lshlrev_b32 v20, 16, v65
    v_lshlrev_b32 v21, 16, v97
    v_mul_f32 v36, v20, v20
    v_mul_f32 v36, v36, v20
    v_fma_f32 v36, v36, s40, v20
    v_mul_f32 v36, s41, v36
    v_exp_f32 v36, v36
    s_nop 0
    v_add_f32 v36, 1.0, v36
    v_rcp_f32 v37, v36
    s_nop 0
    v_mul_f32 v40, v20, v37
    v_fma_f32 v39, -v40, v36, v20
    v_fma_f32 v38, v39, v37, v40
    v_cmp_o_f32 vcc, v38, v38
    s_nop 1
    v_cndmask_b32 v38, v40, v38, vcc
    v_cvt_pk_bf16_f32 v38, v38, v38
    v_and_b32 v38, 0xffff0000, v38
    v_mul_f32 v38, v38, v21
    v_cvt_pk_bf16_f32 v38, v38, v38
    ds_write_b16 v17, v38 offset:2112
    v_and_b32 v20, 0xffff0000, v65
    v_and_b32 v21, 0xffff0000, v97
    v_mul_f32 v36, v20, v20
    v_mul_f32 v36, v36, v20
    v_fma_f32 v36, v36, s40, v20
    v_mul_f32 v36, s41, v36
    v_exp_f32 v36, v36
    s_nop 0
    v_add_f32 v36, 1.0, v36
    v_rcp_f32 v37, v36
    s_nop 0
    v_mul_f32 v40, v20, v37
    v_fma_f32 v39, -v40, v36, v20
    v_fma_f32 v38, v39, v37, v40
    v_cmp_o_f32 vcc, v38, v38
    s_nop 1
    v_cndmask_b32 v38, v40, v38, vcc
    v_cvt_pk_bf16_f32 v38, v38, v38
    v_and_b32 v38, 0xffff0000, v38
    v_mul_f32 v38, v38, v21
    v_cvt_pk_bf16_f32 v38, v38, v38
    ds_write_b16 v17, v38 offset:3168
    v_lshlrev_b32 v20, 16, v68
    v_lshlrev_b32 v21, 16, v100
    v_mul_f32 v36, v20, v20
    v_mul_f32 v36, v36, v20
    v_fma_f32 v36, v36, s40, v20
    v_mul_f32 v36, s41, v36
    v_exp_f32 v36, v36
    s_nop 0
    v_add_f32 v36, 1.0, v36
    v_rcp_f32 v37, v36
    s_nop 0
    v_mul_f32 v40, v20, v37
    v_fma_f32 v39, -v40, v36, v20
    v_fma_f32 v38, v39, v37, v40
    v_cmp_o_f32 vcc, v38, v38
    s_nop 1
    v_cndmask_b32 v38, v40, v38, vcc
    v_cvt_pk_bf16_f32 v38, v38, v38
    v_and_b32 v38, 0xffff0000, v38
    v_mul_f32 v38, v38, v21
    v_cvt_pk_bf16_f32 v38, v38, v38
    ds_write_b16 v17, v38 offset:128
    v_and_b32 v20, 0xffff0000, v68
    v_and_b32 v21, 0xffff0000, v100
    v_mul_f32 v36, v20, v20
    v_mul_f32 v36, v36, v20
    v_fma_f32 v36, v36, s40, v20
    v_mul_f32 v36, s41, v36
    v_exp_f32 v36, v36
    s_nop 0
    v_add_f32 v36, 1.0, v36
    v_rcp_f32 v37, v36
    s_nop 0
    v_mul_f32 v40, v20, v37
    v_fma_f32 v39, -v40, v36, v20
    v_fma_f32 v38, v39, v37, v40
    v_cmp_o_f32 vcc, v38, v38
    s_nop 1
    v_cndmask_b32 v38, v40, v38, vcc
    v_cvt_pk_bf16_f32 v38, v38, v38
    v_and_b32 v38, 0xffff0000, v38
    v_mul_f32 v38, v38, v21
    v_cvt_pk_bf16_f32 v38, v38, v38
    ds_write_b16 v17, v38 offset:1184
    v_lshlrev_b32 v20, 16, v69
    v_lshlrev_b32 v21, 16, v101
    v_mul_f32 v36, v20, v20
    v_mul_f32 v36, v36, v20
    v_fma_f32 v36, v36, s40, v20
    v_mul_f32 v36, s41, v36
    v_exp_f32 v36, v36
    s_nop 0
    v_add_f32 v36, 1.0, v36
    v_rcp_f32 v37, v36
    s_nop 0
    v_mul_f32 v40, v20, v37
    v_fma_f32 v39, -v40, v36, v20
    v_fma_f32 v38, v39, v37, v40
    v_cmp_o_f32 vcc, v38, v38
    s_nop 1
    v_cndmask_b32 v38, v40, v38, vcc
    v_cvt_pk_bf16_f32 v38, v38, v38
    v_and_b32 v38, 0xffff0000, v38
    v_mul_f32 v38, v38, v21
    v_cvt_pk_bf16_f32 v38, v38, v38
    ds_write_b16 v17, v38 offset:2240
    v_and_b32 v20, 0xffff0000, v69
    v_and_b32 v21, 0xffff0000, v101
    v_mul_f32 v36, v20, v20
    v_mul_f32 v36, v36, v20
    v_fma_f32 v36, v36, s40, v20
    v_mul_f32 v36, s41, v36
    v_exp_f32 v36, v36
    s_nop 0
    v_add_f32 v36, 1.0, v36
    v_rcp_f32 v37, v36
    s_nop 0
    v_mul_f32 v40, v20, v37
    v_fma_f32 v39, -v40, v36, v20
    v_fma_f32 v38, v39, v37, v40
    v_cmp_o_f32 vcc, v38, v38
    s_nop 1
    v_cndmask_b32 v38, v40, v38, vcc
    v_cvt_pk_bf16_f32 v38, v38, v38
    v_and_b32 v38, 0xffff0000, v38
    v_mul_f32 v38, v38, v21
    v_cvt_pk_bf16_f32 v38, v38, v38
    ds_write_b16 v17, v38 offset:3296
    v_lshlrev_b32 v20, 16, v72
    v_lshlrev_b32 v21, 16, v104
    v_mul_f32 v36, v20, v20
    v_mul_f32 v36, v36, v20
    v_fma_f32 v36, v36, s40, v20
    v_mul_f32 v36, s41, v36
    v_exp_f32 v36, v36
    s_nop 0
    v_add_f32 v36, 1.0, v36
    v_rcp_f32 v37, v36
    s_nop 0
    v_mul_f32 v40, v20, v37
    v_fma_f32 v39, -v40, v36, v20
    v_fma_f32 v38, v39, v37, v40
    v_cmp_o_f32 vcc, v38, v38
    s_nop 1
    v_cndmask_b32 v38, v40, v38, vcc
    v_cvt_pk_bf16_f32 v38, v38, v38
    v_and_b32 v38, 0xffff0000, v38
    v_mul_f32 v38, v38, v21
    v_cvt_pk_bf16_f32 v38, v38, v38
    ds_write_b16 v17, v38 offset:256
    v_and_b32 v20, 0xffff0000, v72
    v_and_b32 v21, 0xffff0000, v104
    v_mul_f32 v36, v20, v20
    v_mul_f32 v36, v36, v20
    v_fma_f32 v36, v36, s40, v20
    v_mul_f32 v36, s41, v36
    v_exp_f32 v36, v36
    s_nop 0
    v_add_f32 v36, 1.0, v36
    v_rcp_f32 v37, v36
    s_nop 0
    v_mul_f32 v40, v20, v37
    v_fma_f32 v39, -v40, v36, v20
    v_fma_f32 v38, v39, v37, v40
    v_cmp_o_f32 vcc, v38, v38
    s_nop 1
    v_cndmask_b32 v38, v40, v38, vcc
    v_cvt_pk_bf16_f32 v38, v38, v38
    v_and_b32 v38, 0xffff0000, v38
    v_mul_f32 v38, v38, v21
    v_cvt_pk_bf16_f32 v38, v38, v38
    ds_write_b16 v17, v38 offset:1312
    v_lshlrev_b32 v20, 16, v73
    v_lshlrev_b32 v21, 16, v105
    v_mul_f32 v36, v20, v20
    v_mul_f32 v36, v36, v20
    v_fma_f32 v36, v36, s40, v20
    v_mul_f32 v36, s41, v36
    v_exp_f32 v36, v36
    s_nop 0
    v_add_f32 v36, 1.0, v36
    v_rcp_f32 v37, v36
    s_nop 0
    v_mul_f32 v40, v20, v37
    v_fma_f32 v39, -v40, v36, v20
    v_fma_f32 v38, v39, v37, v40
    v_cmp_o_f32 vcc, v38, v38
    s_nop 1
    v_cndmask_b32 v38, v40, v38, vcc
    v_cvt_pk_bf16_f32 v38, v38, v38
    v_and_b32 v38, 0xffff0000, v38
    v_mul_f32 v38, v38, v21
    v_cvt_pk_bf16_f32 v38, v38, v38
    ds_write_b16 v17, v38 offset:2368
    v_and_b32 v20, 0xffff0000, v73
    v_and_b32 v21, 0xffff0000, v105
    v_mul_f32 v36, v20, v20
    v_mul_f32 v36, v36, v20
    v_fma_f32 v36, v36, s40, v20
    v_mul_f32 v36, s41, v36
    v_exp_f32 v36, v36
    s_nop 0
    v_add_f32 v36, 1.0, v36
    v_rcp_f32 v37, v36
    s_nop 0
    v_mul_f32 v40, v20, v37
    v_fma_f32 v39, -v40, v36, v20
    v_fma_f32 v38, v39, v37, v40
    v_cmp_o_f32 vcc, v38, v38
    s_nop 1
    v_cndmask_b32 v38, v40, v38, vcc
    v_cvt_pk_bf16_f32 v38, v38, v38
    v_and_b32 v38, 0xffff0000, v38
    v_mul_f32 v38, v38, v21
    v_cvt_pk_bf16_f32 v38, v38, v38
    ds_write_b16 v17, v38 offset:3424
    v_lshlrev_b32 v20, 16, v76
    v_lshlrev_b32 v21, 16, v108
    v_mul_f32 v36, v20, v20
    v_mul_f32 v36, v36, v20
    v_fma_f32 v36, v36, s40, v20
    v_mul_f32 v36, s41, v36
    v_exp_f32 v36, v36
    s_nop 0
    v_add_f32 v36, 1.0, v36
    v_rcp_f32 v37, v36
    s_nop 0
    v_mul_f32 v40, v20, v37
    v_fma_f32 v39, -v40, v36, v20
    v_fma_f32 v38, v39, v37, v40
    v_cmp_o_f32 vcc, v38, v38
    s_nop 1
    v_cndmask_b32 v38, v40, v38, vcc
    v_cvt_pk_bf16_f32 v38, v38, v38
    v_and_b32 v38, 0xffff0000, v38
    v_mul_f32 v38, v38, v21
    v_cvt_pk_bf16_f32 v38, v38, v38
    ds_write_b16 v17, v38 offset:384
    v_and_b32 v20, 0xffff0000, v76
    v_and_b32 v21, 0xffff0000, v108
    v_mul_f32 v36, v20, v20
    v_mul_f32 v36, v36, v20
    v_fma_f32 v36, v36, s40, v20
    v_mul_f32 v36, s41, v36
    v_exp_f32 v36, v36
    s_nop 0
    v_add_f32 v36, 1.0, v36
    v_rcp_f32 v37, v36
    s_nop 0
    v_mul_f32 v40, v20, v37
    v_fma_f32 v39, -v40, v36, v20
    v_fma_f32 v38, v39, v37, v40
    v_cmp_o_f32 vcc, v38, v38
    s_nop 1
    v_cndmask_b32 v38, v40, v38, vcc
    v_cvt_pk_bf16_f32 v38, v38, v38
    v_and_b32 v38, 0xffff0000, v38
    v_mul_f32 v38, v38, v21
    v_cvt_pk_bf16_f32 v38, v38, v38
    ds_write_b16 v17, v38 offset:1440
    v_lshlrev_b32 v20, 16, v77
    v_lshlrev_b32 v21, 16, v109
    v_mul_f32 v36, v20, v20
    v_mul_f32 v36, v36, v20
    v_fma_f32 v36, v36, s40, v20
    v_mul_f32 v36, s41, v36
    v_exp_f32 v36, v36
    s_nop 0
    v_add_f32 v36, 1.0, v36
    v_rcp_f32 v37, v36
    s_nop 0
    v_mul_f32 v40, v20, v37
    v_fma_f32 v39, -v40, v36, v20
    v_fma_f32 v38, v39, v37, v40
    v_cmp_o_f32 vcc, v38, v38
    s_nop 1
    v_cndmask_b32 v38, v40, v38, vcc
    v_cvt_pk_bf16_f32 v38, v38, v38
    v_and_b32 v38, 0xffff0000, v38
    v_mul_f32 v38, v38, v21
    v_cvt_pk_bf16_f32 v38, v38, v38
    ds_write_b16 v17, v38 offset:2496
    v_and_b32 v20, 0xffff0000, v77
    v_and_b32 v21, 0xffff0000, v109
    v_mul_f32 v36, v20, v20
    v_mul_f32 v36, v36, v20
    v_fma_f32 v36, v36, s40, v20
    v_mul_f32 v36, s41, v36
    v_exp_f32 v36, v36
    s_nop 0
    v_add_f32 v36, 1.0, v36
    v_rcp_f32 v37, v36
    s_nop 0
    v_mul_f32 v40, v20, v37
    v_fma_f32 v39, -v40, v36, v20
    v_fma_f32 v38, v39, v37, v40
    v_cmp_o_f32 vcc, v38, v38
    s_nop 1
    v_cndmask_b32 v38, v40, v38, vcc
    v_cvt_pk_bf16_f32 v38, v38, v38
    v_and_b32 v38, 0xffff0000, v38
    v_mul_f32 v38, v38, v21
    v_cvt_pk_bf16_f32 v38, v38, v38
    ds_write_b16 v17, v38 offset:3552
    v_lshlrev_b32 v20, 16, v80
    v_lshlrev_b32 v21, 16, v112
    v_mul_f32 v36, v20, v20
    v_mul_f32 v36, v36, v20
    v_fma_f32 v36, v36, s40, v20
    v_mul_f32 v36, s41, v36
    v_exp_f32 v36, v36
    s_nop 0
    v_add_f32 v36, 1.0, v36
    v_rcp_f32 v37, v36
    s_nop 0
    v_mul_f32 v40, v20, v37
    v_fma_f32 v39, -v40, v36, v20
    v_fma_f32 v38, v39, v37, v40
    v_cmp_o_f32 vcc, v38, v38
    s_nop 1
    v_cndmask_b32 v38, v40, v38, vcc
    v_cvt_pk_bf16_f32 v38, v38, v38
    v_and_b32 v38, 0xffff0000, v38
    v_mul_f32 v38, v38, v21
    v_cvt_pk_bf16_f32 v38, v38, v38
    ds_write_b16 v17, v38 offset:512
    v_and_b32 v20, 0xffff0000, v80
    v_and_b32 v21, 0xffff0000, v112
    v_mul_f32 v36, v20, v20
    v_mul_f32 v36, v36, v20
    v_fma_f32 v36, v36, s40, v20
    v_mul_f32 v36, s41, v36
    v_exp_f32 v36, v36
    s_nop 0
    v_add_f32 v36, 1.0, v36
    v_rcp_f32 v37, v36
    s_nop 0
    v_mul_f32 v40, v20, v37
    v_fma_f32 v39, -v40, v36, v20
    v_fma_f32 v38, v39, v37, v40
    v_cmp_o_f32 vcc, v38, v38
    s_nop 1
    v_cndmask_b32 v38, v40, v38, vcc
    v_cvt_pk_bf16_f32 v38, v38, v38
    v_and_b32 v38, 0xffff0000, v38
    v_mul_f32 v38, v38, v21
    v_cvt_pk_bf16_f32 v38, v38, v38
    ds_write_b16 v17, v38 offset:1568
    v_lshlrev_b32 v20, 16, v81
    v_lshlrev_b32 v21, 16, v113
    v_mul_f32 v36, v20, v20
    v_mul_f32 v36, v36, v20
    v_fma_f32 v36, v36, s40, v20
    v_mul_f32 v36, s41, v36
    v_exp_f32 v36, v36
    s_nop 0
    v_add_f32 v36, 1.0, v36
    v_rcp_f32 v37, v36
    s_nop 0
    v_mul_f32 v40, v20, v37
    v_fma_f32 v39, -v40, v36, v20
    v_fma_f32 v38, v39, v37, v40
    v_cmp_o_f32 vcc, v38, v38
    s_nop 1
    v_cndmask_b32 v38, v40, v38, vcc
    v_cvt_pk_bf16_f32 v38, v38, v38
    v_and_b32 v38, 0xffff0000, v38
    v_mul_f32 v38, v38, v21
    v_cvt_pk_bf16_f32 v38, v38, v38
    ds_write_b16 v17, v38 offset:2624
    v_and_b32 v20, 0xffff0000, v81
    v_and_b32 v21, 0xffff0000, v113
    v_mul_f32 v36, v20, v20
    v_mul_f32 v36, v36, v20
    v_fma_f32 v36, v36, s40, v20
    v_mul_f32 v36, s41, v36
    v_exp_f32 v36, v36
    s_nop 0
    v_add_f32 v36, 1.0, v36
    v_rcp_f32 v37, v36
    s_nop 0
    v_mul_f32 v40, v20, v37
    v_fma_f32 v39, -v40, v36, v20
    v_fma_f32 v38, v39, v37, v40
    v_cmp_o_f32 vcc, v38, v38
    s_nop 1
    v_cndmask_b32 v38, v40, v38, vcc
    v_cvt_pk_bf16_f32 v38, v38, v38
    v_and_b32 v38, 0xffff0000, v38
    v_mul_f32 v38, v38, v21
    v_cvt_pk_bf16_f32 v38, v38, v38
    ds_write_b16 v17, v38 offset:3680
    v_lshlrev_b32 v20, 16, v84
    v_lshlrev_b32 v21, 16, v116
    v_mul_f32 v36, v20, v20
    v_mul_f32 v36, v36, v20
    v_fma_f32 v36, v36, s40, v20
    v_mul_f32 v36, s41, v36
    v_exp_f32 v36, v36
    s_nop 0
    v_add_f32 v36, 1.0, v36
    v_rcp_f32 v37, v36
    s_nop 0
    v_mul_f32 v40, v20, v37
    v_fma_f32 v39, -v40, v36, v20
    v_fma_f32 v38, v39, v37, v40
    v_cmp_o_f32 vcc, v38, v38
    s_nop 1
    v_cndmask_b32 v38, v40, v38, vcc
    v_cvt_pk_bf16_f32 v38, v38, v38
    v_and_b32 v38, 0xffff0000, v38
    v_mul_f32 v38, v38, v21
    v_cvt_pk_bf16_f32 v38, v38, v38
    ds_write_b16 v17, v38 offset:640
    v_and_b32 v20, 0xffff0000, v84
    v_and_b32 v21, 0xffff0000, v116
    v_mul_f32 v36, v20, v20
    v_mul_f32 v36, v36, v20
    v_fma_f32 v36, v36, s40, v20
    v_mul_f32 v36, s41, v36
    v_exp_f32 v36, v36
    s_nop 0
    v_add_f32 v36, 1.0, v36
    v_rcp_f32 v37, v36
    s_nop 0
    v_mul_f32 v40, v20, v37
    v_fma_f32 v39, -v40, v36, v20
    v_fma_f32 v38, v39, v37, v40
    v_cmp_o_f32 vcc, v38, v38
    s_nop 1
    v_cndmask_b32 v38, v40, v38, vcc
    v_cvt_pk_bf16_f32 v38, v38, v38
    v_and_b32 v38, 0xffff0000, v38
    v_mul_f32 v38, v38, v21
    v_cvt_pk_bf16_f32 v38, v38, v38
    ds_write_b16 v17, v38 offset:1696
    v_lshlrev_b32 v20, 16, v85
    v_lshlrev_b32 v21, 16, v117
    v_mul_f32 v36, v20, v20
    v_mul_f32 v36, v36, v20
    v_fma_f32 v36, v36, s40, v20
    v_mul_f32 v36, s41, v36
    v_exp_f32 v36, v36
    s_nop 0
    v_add_f32 v36, 1.0, v36
    v_rcp_f32 v37, v36
    s_nop 0
    v_mul_f32 v40, v20, v37
    v_fma_f32 v39, -v40, v36, v20
    v_fma_f32 v38, v39, v37, v40
    v_cmp_o_f32 vcc, v38, v38
    s_nop 1
    v_cndmask_b32 v38, v40, v38, vcc
    v_cvt_pk_bf16_f32 v38, v38, v38
    v_and_b32 v38, 0xffff0000, v38
    v_mul_f32 v38, v38, v21
    v_cvt_pk_bf16_f32 v38, v38, v38
    ds_write_b16 v17, v38 offset:2752
    v_and_b32 v20, 0xffff0000, v85
    v_and_b32 v21, 0xffff0000, v117
    v_mul_f32 v36, v20, v20
    v_mul_f32 v36, v36, v20
    v_fma_f32 v36, v36, s40, v20
    v_mul_f32 v36, s41, v36
    v_exp_f32 v36, v36
    s_nop 0
    v_add_f32 v36, 1.0, v36
    v_rcp_f32 v37, v36
    s_nop 0
    v_mul_f32 v40, v20, v37
    v_fma_f32 v39, -v40, v36, v20
    v_fma_f32 v38, v39, v37, v40
    v_cmp_o_f32 vcc, v38, v38
    s_nop 1
    v_cndmask_b32 v38, v40, v38, vcc
    v_cvt_pk_bf16_f32 v38, v38, v38
    v_and_b32 v38, 0xffff0000, v38
    v_mul_f32 v38, v38, v21
    v_cvt_pk_bf16_f32 v38, v38, v38
    ds_write_b16 v17, v38 offset:3808
    v_lshlrev_b32 v20, 16, v88
    v_lshlrev_b32 v21, 16, v120
    v_mul_f32 v36, v20, v20
    v_mul_f32 v36, v36, v20
    v_fma_f32 v36, v36, s40, v20
    v_mul_f32 v36, s41, v36
    v_exp_f32 v36, v36
    s_nop 0
    v_add_f32 v36, 1.0, v36
    v_rcp_f32 v37, v36
    s_nop 0
    v_mul_f32 v40, v20, v37
    v_fma_f32 v39, -v40, v36, v20
    v_fma_f32 v38, v39, v37, v40
    v_cmp_o_f32 vcc, v38, v38
    s_nop 1
    v_cndmask_b32 v38, v40, v38, vcc
    v_cvt_pk_bf16_f32 v38, v38, v38
    v_and_b32 v38, 0xffff0000, v38
    v_mul_f32 v38, v38, v21
    v_cvt_pk_bf16_f32 v38, v38, v38
    ds_write_b16 v17, v38 offset:768
    v_and_b32 v20, 0xffff0000, v88
    v_and_b32 v21, 0xffff0000, v120
    v_mul_f32 v36, v20, v20
    v_mul_f32 v36, v36, v20
    v_fma_f32 v36, v36, s40, v20
    v_mul_f32 v36, s41, v36
    v_exp_f32 v36, v36
    s_nop 0
    v_add_f32 v36, 1.0, v36
    v_rcp_f32 v37, v36
    s_nop 0
    v_mul_f32 v40, v20, v37
    v_fma_f32 v39, -v40, v36, v20
    v_fma_f32 v38, v39, v37, v40
    v_cmp_o_f32 vcc, v38, v38
    s_nop 1
    v_cndmask_b32 v38, v40, v38, vcc
    v_cvt_pk_bf16_f32 v38, v38, v38
    v_and_b32 v38, 0xffff0000, v38
    v_mul_f32 v38, v38, v21
    v_cvt_pk_bf16_f32 v38, v38, v38
    ds_write_b16 v17, v38 offset:1824
    v_lshlrev_b32 v20, 16, v89
    v_lshlrev_b32 v21, 16, v121
    v_mul_f32 v36, v20, v20
    v_mul_f32 v36, v36, v20
    v_fma_f32 v36, v36, s40, v20
    v_mul_f32 v36, s41, v36
    v_exp_f32 v36, v36
    s_nop 0
    v_add_f32 v36, 1.0, v36
    v_rcp_f32 v37, v36
    s_nop 0
    v_mul_f32 v40, v20, v37
    v_fma_f32 v39, -v40, v36, v20
    v_fma_f32 v38, v39, v37, v40
    v_cmp_o_f32 vcc, v38, v38
    s_nop 1
    v_cndmask_b32 v38, v40, v38, vcc
    v_cvt_pk_bf16_f32 v38, v38, v38
    v_and_b32 v38, 0xffff0000, v38
    v_mul_f32 v38, v38, v21
    v_cvt_pk_bf16_f32 v38, v38, v38
    ds_write_b16 v17, v38 offset:2880
    v_and_b32 v20, 0xffff0000, v89
    v_and_b32 v21, 0xffff0000, v121
    v_mul_f32 v36, v20, v20
    v_mul_f32 v36, v36, v20
    v_fma_f32 v36, v36, s40, v20
    v_mul_f32 v36, s41, v36
    v_exp_f32 v36, v36
    s_nop 0
    v_add_f32 v36, 1.0, v36
    v_rcp_f32 v37, v36
    s_nop 0
    v_mul_f32 v40, v20, v37
    v_fma_f32 v39, -v40, v36, v20
    v_fma_f32 v38, v39, v37, v40
    v_cmp_o_f32 vcc, v38, v38
    s_nop 1
    v_cndmask_b32 v38, v40, v38, vcc
    v_cvt_pk_bf16_f32 v38, v38, v38
    v_and_b32 v38, 0xffff0000, v38
    v_mul_f32 v38, v38, v21
    v_cvt_pk_bf16_f32 v38, v38, v38
    ds_write_b16 v17, v38 offset:3936
    v_lshlrev_b32 v20, 16, v92
    v_lshlrev_b32 v21, 16, v124
    v_mul_f32 v36, v20, v20
    v_mul_f32 v36, v36, v20
    v_fma_f32 v36, v36, s40, v20
    v_mul_f32 v36, s41, v36
    v_exp_f32 v36, v36
    s_nop 0
    v_add_f32 v36, 1.0, v36
    v_rcp_f32 v37, v36
    s_nop 0
    v_mul_f32 v40, v20, v37
    v_fma_f32 v39, -v40, v36, v20
    v_fma_f32 v38, v39, v37, v40
    v_cmp_o_f32 vcc, v38, v38
    s_nop 1
    v_cndmask_b32 v38, v40, v38, vcc
    v_cvt_pk_bf16_f32 v38, v38, v38
    v_and_b32 v38, 0xffff0000, v38
    v_mul_f32 v38, v38, v21
    v_cvt_pk_bf16_f32 v38, v38, v38
    ds_write_b16 v17, v38 offset:896
    v_and_b32 v20, 0xffff0000, v92
    v_and_b32 v21, 0xffff0000, v124
    v_mul_f32 v36, v20, v20
    v_mul_f32 v36, v36, v20
    v_fma_f32 v36, v36, s40, v20
    v_mul_f32 v36, s41, v36
    v_exp_f32 v36, v36
    s_nop 0
    v_add_f32 v36, 1.0, v36
    v_rcp_f32 v37, v36
    s_nop 0
    v_mul_f32 v40, v20, v37
    v_fma_f32 v39, -v40, v36, v20
    v_fma_f32 v38, v39, v37, v40
    v_cmp_o_f32 vcc, v38, v38
    s_nop 1
    v_cndmask_b32 v38, v40, v38, vcc
    v_cvt_pk_bf16_f32 v38, v38, v38
    v_and_b32 v38, 0xffff0000, v38
    v_mul_f32 v38, v38, v21
    v_cvt_pk_bf16_f32 v38, v38, v38
    ds_write_b16 v17, v38 offset:1952
    v_lshlrev_b32 v20, 16, v93
    v_lshlrev_b32 v21, 16, v125
    v_mul_f32 v36, v20, v20
    v_mul_f32 v36, v36, v20
    v_fma_f32 v36, v36, s40, v20
    v_mul_f32 v36, s41, v36
    v_exp_f32 v36, v36
    s_nop 0
    v_add_f32 v36, 1.0, v36
    v_rcp_f32 v37, v36
    s_nop 0
    v_mul_f32 v40, v20, v37
    v_fma_f32 v39, -v40, v36, v20
    v_fma_f32 v38, v39, v37, v40
    v_cmp_o_f32 vcc, v38, v38
    s_nop 1
    v_cndmask_b32 v38, v40, v38, vcc
    v_cvt_pk_bf16_f32 v38, v38, v38
    v_and_b32 v38, 0xffff0000, v38
    v_mul_f32 v38, v38, v21
    v_cvt_pk_bf16_f32 v38, v38, v38
    ds_write_b16 v17, v38 offset:3008
    v_and_b32 v20, 0xffff0000, v93
    v_and_b32 v21, 0xffff0000, v125
    v_mul_f32 v36, v20, v20
    v_mul_f32 v36, v36, v20
    v_fma_f32 v36, v36, s40, v20
    v_mul_f32 v36, s41, v36
    v_exp_f32 v36, v36
    s_nop 0
    v_add_f32 v36, 1.0, v36
    v_rcp_f32 v37, v36
    s_nop 0
    v_mul_f32 v40, v20, v37
    v_fma_f32 v39, -v40, v36, v20
    v_fma_f32 v38, v39, v37, v40
    v_cmp_o_f32 vcc, v38, v38
    s_nop 1
    v_cndmask_b32 v38, v40, v38, vcc
    v_cvt_pk_bf16_f32 v38, v38, v38
    v_and_b32 v38, 0xffff0000, v38
    v_mul_f32 v38, v38, v21
    v_cvt_pk_bf16_f32 v38, v38, v38
    ds_write_b16 v17, v38 offset:4064
    s_waitcnt lgkmcnt(0)
    v_lshrrev_b32 v24, 4, v1
    v_and_b32 v25, 15, v1
    v_lshrrev_b32 v26, 2, v25
    v_and_b32 v27, 3, v25
    v_lshlrev_b32 v16, 3, v24
    v_add_u32 v16, v16, v26
    v_lshlrev_b32 v16, 7, v16
    v_lshlrev_b32 v27, 3, v27
    v_add_u32 v16, v16, v27
    v_add_u32 v16, 32768, v16
    v_lshrrev_b32 v26, 1, v26
    v_and_b32 v19, 1, v24
    v_lshlrev_b32 v19, 1, v19
    v_or_b32 v19, v19, v26
    v_and_b32 v26, 3, v1
    v_mul_u32_u24 v18, 1056, v26
    v_lshlrev_b32 v24, 4, v24
    v_add_u32 v18, v18, v24
    v_add_u32 v18, 131072, v18
    v_xor_b32 v27, 0, v19
    v_lshlrev_b32 v27, 5, v27
    v_add_u32 v40, v27, v16
    v_xor_b32 v27, 1, v19
    v_lshlrev_b32 v27, 5, v27
    v_add_u32 v41, v27, v16
    v_xor_b32 v27, 2, v19
    v_lshlrev_b32 v27, 5, v27
    v_add_u32 v42, v27, v16
    v_xor_b32 v27, 3, v19
    v_lshlrev_b32 v27, 5, v27
    v_add_u32 v43, v27, v16
    ds_read_b128 v[64:67], v18 offset:0
    ds_read_b128 v[68:71], v18 offset:64
    ds_read_b128 v[72:75], v18 offset:128
    ds_read_b128 v[76:79], v18 offset:192
    ds_read_b128 v[80:83], v18 offset:256
    ds_read_b128 v[84:87], v18 offset:320
    ds_read_b128 v[88:91], v18 offset:384
    ds_read_b128 v[92:95], v18 offset:448
    s_waitcnt lgkmcnt(0)
    ds_read_b128 v[96:99], v18 offset:512
    ds_read_b128 v[100:103], v18 offset:576
    ds_read_b128 v[104:107], v18 offset:640
    ds_read_b128 v[108:111], v18 offset:704
    ds_read_b128 v[112:115], v18 offset:768
    ds_read_b128 v[116:119], v18 offset:832
    ds_read_b128 v[120:123], v18 offset:896
    ds_read_b128 v[124:127], v18 offset:960
    s_waitcnt lgkmcnt(0)
    v_mov_b32 v20, 0
    v_mov_b32 v21, 0
    v_mov_b32 v22, 0
    v_mov_b32 v23, 0
    v_mov_b32 v24, 0
    v_mov_b32 v25, 0
    v_mov_b32 v26, 0
    v_mov_b32 v27, 0
    v_mov_b32 v28, 0
    v_mov_b32 v29, 0
    v_mov_b32 v30, 0
    v_mov_b32 v31, 0
    v_mov_b32 v32, 0
    v_mov_b32 v33, 0
    v_mov_b32 v34, 0
    v_mov_b32 v35, 0
    ds_read_b64_tr_b16 v[128:129], v40 offset:0
    ds_read_b64_tr_b16 v[130:131], v40 offset:512
    ds_read_b64_tr_b16 v[132:133], v40 offset:4096
    ds_read_b64_tr_b16 v[134:135], v40 offset:4608
    ds_read_b64_tr_b16 v[136:137], v40 offset:8192
    ds_read_b64_tr_b16 v[138:139], v40 offset:8704
    ds_read_b64_tr_b16 v[140:141], v40 offset:12288
    ds_read_b64_tr_b16 v[142:143], v40 offset:12800
    s_waitcnt lgkmcnt(6)
    v_mfma_f32_16x16x32_bf16 v[20:23], v[64:67], v[128:131], v[20:23]
    s_waitcnt lgkmcnt(4)
    v_mfma_f32_16x16x32_bf16 v[20:23], v[68:71], v[132:135], v[20:23]
    s_waitcnt lgkmcnt(2)
    v_mfma_f32_16x16x32_bf16 v[20:23], v[72:75], v[136:139], v[20:23]
    s_waitcnt lgkmcnt(0)
    v_mfma_f32_16x16x32_bf16 v[20:23], v[76:79], v[140:143], v[20:23]
    ds_read_b64_tr_b16 v[128:129], v40 offset:16384
    ds_read_b64_tr_b16 v[130:131], v40 offset:16896
    ds_read_b64_tr_b16 v[132:133], v40 offset:20480
    ds_read_b64_tr_b16 v[134:135], v40 offset:20992
    ds_read_b64_tr_b16 v[136:137], v40 offset:24576
    ds_read_b64_tr_b16 v[138:139], v40 offset:25088
    ds_read_b64_tr_b16 v[140:141], v40 offset:28672
    ds_read_b64_tr_b16 v[142:143], v40 offset:29184
    s_waitcnt lgkmcnt(6)
    v_mfma_f32_16x16x32_bf16 v[20:23], v[80:83], v[128:131], v[20:23]
    s_waitcnt lgkmcnt(4)
    v_mfma_f32_16x16x32_bf16 v[20:23], v[84:87], v[132:135], v[20:23]
    s_waitcnt lgkmcnt(2)
    v_mfma_f32_16x16x32_bf16 v[20:23], v[88:91], v[136:139], v[20:23]
    s_waitcnt lgkmcnt(0)
    v_mfma_f32_16x16x32_bf16 v[20:23], v[92:95], v[140:143], v[20:23]
    ds_read_b64_tr_b16 v[128:129], v40 offset:32768
    ds_read_b64_tr_b16 v[130:131], v40 offset:33280
    ds_read_b64_tr_b16 v[132:133], v40 offset:36864
    ds_read_b64_tr_b16 v[134:135], v40 offset:37376
    ds_read_b64_tr_b16 v[136:137], v40 offset:40960
    ds_read_b64_tr_b16 v[138:139], v40 offset:41472
    ds_read_b64_tr_b16 v[140:141], v40 offset:45056
    ds_read_b64_tr_b16 v[142:143], v40 offset:45568
    s_waitcnt lgkmcnt(6)
    v_mfma_f32_16x16x32_bf16 v[20:23], v[96:99], v[128:131], v[20:23]
    s_waitcnt lgkmcnt(4)
    v_mfma_f32_16x16x32_bf16 v[20:23], v[100:103], v[132:135], v[20:23]
    s_waitcnt lgkmcnt(2)
    v_mfma_f32_16x16x32_bf16 v[20:23], v[104:107], v[136:139], v[20:23]
    s_waitcnt lgkmcnt(0)
    v_mfma_f32_16x16x32_bf16 v[20:23], v[108:111], v[140:143], v[20:23]
    ds_read_b64_tr_b16 v[128:129], v40 offset:49152
    ds_read_b64_tr_b16 v[130:131], v40 offset:49664
    ds_read_b64_tr_b16 v[132:133], v40 offset:53248
    ds_read_b64_tr_b16 v[134:135], v40 offset:53760
    ds_read_b64_tr_b16 v[136:137], v40 offset:57344
    ds_read_b64_tr_b16 v[138:139], v40 offset:57856
    ds_read_b64_tr_b16 v[140:141], v40 offset:61440
    ds_read_b64_tr_b16 v[142:143], v40 offset:61952
    s_waitcnt lgkmcnt(6)
    v_mfma_f32_16x16x32_bf16 v[20:23], v[112:115], v[128:131], v[20:23]
    s_waitcnt lgkmcnt(4)
    v_mfma_f32_16x16x32_bf16 v[20:23], v[116:119], v[132:135], v[20:23]
    s_waitcnt lgkmcnt(2)
    v_mfma_f32_16x16x32_bf16 v[20:23], v[120:123], v[136:139], v[20:23]
    s_waitcnt lgkmcnt(0)
    v_mfma_f32_16x16x32_bf16 v[20:23], v[124:127], v[140:143], v[20:23]
    ds_read_b64_tr_b16 v[128:129], v41 offset:0
    ds_read_b64_tr_b16 v[130:131], v41 offset:512
    ds_read_b64_tr_b16 v[132:133], v41 offset:4096
    ds_read_b64_tr_b16 v[134:135], v41 offset:4608
    ds_read_b64_tr_b16 v[136:137], v41 offset:8192
    ds_read_b64_tr_b16 v[138:139], v41 offset:8704
    ds_read_b64_tr_b16 v[140:141], v41 offset:12288
    ds_read_b64_tr_b16 v[142:143], v41 offset:12800
    s_waitcnt lgkmcnt(6)
    v_mfma_f32_16x16x32_bf16 v[24:27], v[64:67], v[128:131], v[24:27]
    s_waitcnt lgkmcnt(4)
    v_mfma_f32_16x16x32_bf16 v[24:27], v[68:71], v[132:135], v[24:27]
    s_waitcnt lgkmcnt(2)
    v_mfma_f32_16x16x32_bf16 v[24:27], v[72:75], v[136:139], v[24:27]
    s_waitcnt lgkmcnt(0)
    v_mfma_f32_16x16x32_bf16 v[24:27], v[76:79], v[140:143], v[24:27]
    ds_read_b64_tr_b16 v[128:129], v41 offset:16384
    ds_read_b64_tr_b16 v[130:131], v41 offset:16896
    ds_read_b64_tr_b16 v[132:133], v41 offset:20480
    ds_read_b64_tr_b16 v[134:135], v41 offset:20992
    ds_read_b64_tr_b16 v[136:137], v41 offset:24576
    ds_read_b64_tr_b16 v[138:139], v41 offset:25088
    ds_read_b64_tr_b16 v[140:141], v41 offset:28672
    ds_read_b64_tr_b16 v[142:143], v41 offset:29184
    s_waitcnt lgkmcnt(6)
    v_mfma_f32_16x16x32_bf16 v[24:27], v[80:83], v[128:131], v[24:27]
    s_waitcnt lgkmcnt(4)
    v_mfma_f32_16x16x32_bf16 v[24:27], v[84:87], v[132:135], v[24:27]
    s_waitcnt lgkmcnt(2)
    v_mfma_f32_16x16x32_bf16 v[24:27], v[88:91], v[136:139], v[24:27]
    s_waitcnt lgkmcnt(0)
    v_mfma_f32_16x16x32_bf16 v[24:27], v[92:95], v[140:143], v[24:27]
    ds_read_b64_tr_b16 v[128:129], v41 offset:32768
    ds_read_b64_tr_b16 v[130:131], v41 offset:33280
    ds_read_b64_tr_b16 v[132:133], v41 offset:36864
    ds_read_b64_tr_b16 v[134:135], v41 offset:37376
    ds_read_b64_tr_b16 v[136:137], v41 offset:40960
    ds_read_b64_tr_b16 v[138:139], v41 offset:41472
    ds_read_b64_tr_b16 v[140:141], v41 offset:45056
    ds_read_b64_tr_b16 v[142:143], v41 offset:45568
    s_waitcnt lgkmcnt(6)
    v_mfma_f32_16x16x32_bf16 v[24:27], v[96:99], v[128:131], v[24:27]
    s_waitcnt lgkmcnt(4)
    v_mfma_f32_16x16x32_bf16 v[24:27], v[100:103], v[132:135], v[24:27]
    s_waitcnt lgkmcnt(2)
    v_mfma_f32_16x16x32_bf16 v[24:27], v[104:107], v[136:139], v[24:27]
    s_waitcnt lgkmcnt(0)
    v_mfma_f32_16x16x32_bf16 v[24:27], v[108:111], v[140:143], v[24:27]
    ds_read_b64_tr_b16 v[128:129], v41 offset:49152
    ds_read_b64_tr_b16 v[130:131], v41 offset:49664
    ds_read_b64_tr_b16 v[132:133], v41 offset:53248
    ds_read_b64_tr_b16 v[134:135], v41 offset:53760
    ds_read_b64_tr_b16 v[136:137], v41 offset:57344
    ds_read_b64_tr_b16 v[138:139], v41 offset:57856
    ds_read_b64_tr_b16 v[140:141], v41 offset:61440
    ds_read_b64_tr_b16 v[142:143], v41 offset:61952
    s_waitcnt lgkmcnt(6)
    v_mfma_f32_16x16x32_bf16 v[24:27], v[112:115], v[128:131], v[24:27]
    s_waitcnt lgkmcnt(4)
    v_mfma_f32_16x16x32_bf16 v[24:27], v[116:119], v[132:135], v[24:27]
    s_waitcnt lgkmcnt(2)
    v_mfma_f32_16x16x32_bf16 v[24:27], v[120:123], v[136:139], v[24:27]
    s_waitcnt lgkmcnt(0)
    v_mfma_f32_16x16x32_bf16 v[24:27], v[124:127], v[140:143], v[24:27]
    ds_read_b64_tr_b16 v[128:129], v42 offset:0
    ds_read_b64_tr_b16 v[130:131], v42 offset:512
    ds_read_b64_tr_b16 v[132:133], v42 offset:4096
    ds_read_b64_tr_b16 v[134:135], v42 offset:4608
    ds_read_b64_tr_b16 v[136:137], v42 offset:8192
    ds_read_b64_tr_b16 v[138:139], v42 offset:8704
    ds_read_b64_tr_b16 v[140:141], v42 offset:12288
    ds_read_b64_tr_b16 v[142:143], v42 offset:12800
    s_waitcnt lgkmcnt(6)
    v_mfma_f32_16x16x32_bf16 v[28:31], v[64:67], v[128:131], v[28:31]
    s_waitcnt lgkmcnt(4)
    v_mfma_f32_16x16x32_bf16 v[28:31], v[68:71], v[132:135], v[28:31]
    s_waitcnt lgkmcnt(2)
    v_mfma_f32_16x16x32_bf16 v[28:31], v[72:75], v[136:139], v[28:31]
    s_waitcnt lgkmcnt(0)
    v_mfma_f32_16x16x32_bf16 v[28:31], v[76:79], v[140:143], v[28:31]
    ds_read_b64_tr_b16 v[128:129], v42 offset:16384
    ds_read_b64_tr_b16 v[130:131], v42 offset:16896
    ds_read_b64_tr_b16 v[132:133], v42 offset:20480
    ds_read_b64_tr_b16 v[134:135], v42 offset:20992
    ds_read_b64_tr_b16 v[136:137], v42 offset:24576
    ds_read_b64_tr_b16 v[138:139], v42 offset:25088
    ds_read_b64_tr_b16 v[140:141], v42 offset:28672
    ds_read_b64_tr_b16 v[142:143], v42 offset:29184
    s_waitcnt lgkmcnt(6)
    v_mfma_f32_16x16x32_bf16 v[28:31], v[80:83], v[128:131], v[28:31]
    s_waitcnt lgkmcnt(4)
    v_mfma_f32_16x16x32_bf16 v[28:31], v[84:87], v[132:135], v[28:31]
    s_waitcnt lgkmcnt(2)
    v_mfma_f32_16x16x32_bf16 v[28:31], v[88:91], v[136:139], v[28:31]
    s_waitcnt lgkmcnt(0)
    v_mfma_f32_16x16x32_bf16 v[28:31], v[92:95], v[140:143], v[28:31]
    ds_read_b64_tr_b16 v[128:129], v42 offset:32768
    ds_read_b64_tr_b16 v[130:131], v42 offset:33280
    ds_read_b64_tr_b16 v[132:133], v42 offset:36864
    ds_read_b64_tr_b16 v[134:135], v42 offset:37376
    ds_read_b64_tr_b16 v[136:137], v42 offset:40960
    ds_read_b64_tr_b16 v[138:139], v42 offset:41472
    ds_read_b64_tr_b16 v[140:141], v42 offset:45056
    ds_read_b64_tr_b16 v[142:143], v42 offset:45568
    s_waitcnt lgkmcnt(6)
    v_mfma_f32_16x16x32_bf16 v[28:31], v[96:99], v[128:131], v[28:31]
    s_waitcnt lgkmcnt(4)
    v_mfma_f32_16x16x32_bf16 v[28:31], v[100:103], v[132:135], v[28:31]
    s_waitcnt lgkmcnt(2)
    v_mfma_f32_16x16x32_bf16 v[28:31], v[104:107], v[136:139], v[28:31]
    s_waitcnt lgkmcnt(0)
    v_mfma_f32_16x16x32_bf16 v[28:31], v[108:111], v[140:143], v[28:31]
    ds_read_b64_tr_b16 v[128:129], v42 offset:49152
    ds_read_b64_tr_b16 v[130:131], v42 offset:49664
    ds_read_b64_tr_b16 v[132:133], v42 offset:53248
    ds_read_b64_tr_b16 v[134:135], v42 offset:53760
    ds_read_b64_tr_b16 v[136:137], v42 offset:57344
    ds_read_b64_tr_b16 v[138:139], v42 offset:57856
    ds_read_b64_tr_b16 v[140:141], v42 offset:61440
    ds_read_b64_tr_b16 v[142:143], v42 offset:61952
    s_waitcnt lgkmcnt(6)
    v_mfma_f32_16x16x32_bf16 v[28:31], v[112:115], v[128:131], v[28:31]
    s_waitcnt lgkmcnt(4)
    v_mfma_f32_16x16x32_bf16 v[28:31], v[116:119], v[132:135], v[28:31]
    s_waitcnt lgkmcnt(2)
    v_mfma_f32_16x16x32_bf16 v[28:31], v[120:123], v[136:139], v[28:31]
    s_waitcnt lgkmcnt(0)
    v_mfma_f32_16x16x32_bf16 v[28:31], v[124:127], v[140:143], v[28:31]
    ds_read_b64_tr_b16 v[128:129], v43 offset:0
    ds_read_b64_tr_b16 v[130:131], v43 offset:512
    ds_read_b64_tr_b16 v[132:133], v43 offset:4096
    ds_read_b64_tr_b16 v[134:135], v43 offset:4608
    ds_read_b64_tr_b16 v[136:137], v43 offset:8192
    ds_read_b64_tr_b16 v[138:139], v43 offset:8704
    ds_read_b64_tr_b16 v[140:141], v43 offset:12288
    ds_read_b64_tr_b16 v[142:143], v43 offset:12800
    s_waitcnt lgkmcnt(6)
    v_mfma_f32_16x16x32_bf16 v[32:35], v[64:67], v[128:131], v[32:35]
    s_waitcnt lgkmcnt(4)
    v_mfma_f32_16x16x32_bf16 v[32:35], v[68:71], v[132:135], v[32:35]
    s_waitcnt lgkmcnt(2)
    v_mfma_f32_16x16x32_bf16 v[32:35], v[72:75], v[136:139], v[32:35]
    s_waitcnt lgkmcnt(0)
    v_mfma_f32_16x16x32_bf16 v[32:35], v[76:79], v[140:143], v[32:35]
    ds_read_b64_tr_b16 v[128:129], v43 offset:16384
    ds_read_b64_tr_b16 v[130:131], v43 offset:16896
    ds_read_b64_tr_b16 v[132:133], v43 offset:20480
    ds_read_b64_tr_b16 v[134:135], v43 offset:20992
    ds_read_b64_tr_b16 v[136:137], v43 offset:24576
    ds_read_b64_tr_b16 v[138:139], v43 offset:25088
    ds_read_b64_tr_b16 v[140:141], v43 offset:28672
    ds_read_b64_tr_b16 v[142:143], v43 offset:29184
    s_waitcnt lgkmcnt(6)
    v_mfma_f32_16x16x32_bf16 v[32:35], v[80:83], v[128:131], v[32:35]
    s_waitcnt lgkmcnt(4)
    v_mfma_f32_16x16x32_bf16 v[32:35], v[84:87], v[132:135], v[32:35]
    s_waitcnt lgkmcnt(2)
    v_mfma_f32_16x16x32_bf16 v[32:35], v[88:91], v[136:139], v[32:35]
    s_waitcnt lgkmcnt(0)
    v_mfma_f32_16x16x32_bf16 v[32:35], v[92:95], v[140:143], v[32:35]
    ds_read_b64_tr_b16 v[128:129], v43 offset:32768
    ds_read_b64_tr_b16 v[130:131], v43 offset:33280
    ds_read_b64_tr_b16 v[132:133], v43 offset:36864
    ds_read_b64_tr_b16 v[134:135], v43 offset:37376
    ds_read_b64_tr_b16 v[136:137], v43 offset:40960
    ds_read_b64_tr_b16 v[138:139], v43 offset:41472
    ds_read_b64_tr_b16 v[140:141], v43 offset:45056
    ds_read_b64_tr_b16 v[142:143], v43 offset:45568
    s_waitcnt lgkmcnt(6)
    v_mfma_f32_16x16x32_bf16 v[32:35], v[96:99], v[128:131], v[32:35]
    s_waitcnt lgkmcnt(4)
    v_mfma_f32_16x16x32_bf16 v[32:35], v[100:103], v[132:135], v[32:35]
    s_waitcnt lgkmcnt(2)
    v_mfma_f32_16x16x32_bf16 v[32:35], v[104:107], v[136:139], v[32:35]
    s_waitcnt lgkmcnt(0)
    v_mfma_f32_16x16x32_bf16 v[32:35], v[108:111], v[140:143], v[32:35]
    ds_read_b64_tr_b16 v[128:129], v43 offset:49152
    ds_read_b64_tr_b16 v[130:131], v43 offset:49664
    ds_read_b64_tr_b16 v[132:133], v43 offset:53248
    ds_read_b64_tr_b16 v[134:135], v43 offset:53760
    ds_read_b64_tr_b16 v[136:137], v43 offset:57344
    ds_read_b64_tr_b16 v[138:139], v43 offset:57856
    ds_read_b64_tr_b16 v[140:141], v43 offset:61440
    ds_read_b64_tr_b16 v[142:143], v43 offset:61952
    s_waitcnt lgkmcnt(6)
    v_mfma_f32_16x16x32_bf16 v[32:35], v[112:115], v[128:131], v[32:35]
    s_waitcnt lgkmcnt(4)
    v_mfma_f32_16x16x32_bf16 v[32:35], v[116:119], v[132:135], v[32:35]
    s_waitcnt lgkmcnt(2)
    v_mfma_f32_16x16x32_bf16 v[32:35], v[120:123], v[136:139], v[32:35]
    s_waitcnt lgkmcnt(0)
    v_mfma_f32_16x16x32_bf16 v[32:35], v[124:127], v[140:143], v[32:35]
    v_lshlrev_b32 v16, 2, v1
    s_mov_b64 exec, 0xffff
    s_mul_i32 s33, s27, 0
    s_add_u32 s33, s33, s26
    buffer_store_dword v20, v16, s[16:19], s33 offen offset:0 sc1
    buffer_store_dword v24, v16, s[16:19], s33 offen offset:64 sc1
    buffer_store_dword v28, v16, s[16:19], s33 offen offset:128 sc1
    s_nop 0
    buffer_store_dword v32, v16, s[16:19], s33 offen offset:192 sc1
    s_mul_i32 s33, s27, 1
    s_add_u32 s33, s33, s26
    buffer_store_dword v21, v16, s[16:19], s33 offen offset:0 sc1
    buffer_store_dword v25, v16, s[16:19], s33 offen offset:64 sc1
    buffer_store_dword v29, v16, s[16:19], s33 offen offset:128 sc1
    buffer_store_dword v33, v16, s[16:19], s33 offen offset:192 sc1
    s_mul_i32 s33, s27, 2
    s_add_u32 s33, s33, s26
    buffer_store_dword v22, v16, s[16:19], s33 offen offset:0 sc1
    buffer_store_dword v26, v16, s[16:19], s33 offen offset:64 sc1
    buffer_store_dword v30, v16, s[16:19], s33 offen offset:128 sc1
    buffer_store_dword v34, v16, s[16:19], s33 offen offset:192 sc1
    s_mul_i32 s33, s27, 3
    s_add_u32 s33, s33, s26
    buffer_store_dword v23, v16, s[16:19], s33 offen offset:0 sc1
    buffer_store_dword v27, v16, s[16:19], s33 offen offset:64 sc1
    buffer_store_dword v31, v16, s[16:19], s33 offen offset:128 sc1
    buffer_store_dword v35, v16, s[16:19], s33 offen offset:192 sc1
    s_mov_b64 exec, -1
    s_add_u32 s32, s74, 0
    s_mul_i32 s32, s32, 3072
    s_add_u32 s32, s32, s30
    buffer_load_dwordx4 v[64:67], v2, s[8:11], s32 offen offset:0 nt
    buffer_load_dwordx4 v[68:71], v2, s[8:11], s32 offen offset:128 nt
    buffer_load_dwordx4 v[72:75], v2, s[8:11], s32 offen offset:256 nt
    buffer_load_dwordx4 v[76:79], v2, s[12:15], s32 offen offset:0 nt
    buffer_load_dwordx4 v[80:83], v2, s[12:15], s32 offen offset:128 nt
    buffer_load_dwordx4 v[84:87], v2, s[12:15], s32 offen offset:256 nt
    s_add_u32 s32, s74, 7
    s_mul_i32 s32, s32, 3072
    s_add_u32 s32, s32, s30
    buffer_load_dwordx4 v[88:91], v2, s[8:11], s32 offen offset:0 nt
    buffer_load_dwordx4 v[92:95], v2, s[8:11], s32 offen offset:128 nt
    buffer_load_dwordx4 v[96:99], v2, s[8:11], s32 offen offset:256 nt
    buffer_load_dwordx4 v[100:103], v2, s[12:15], s32 offen offset:0 nt
    buffer_load_dwordx4 v[104:107], v2, s[12:15], s32 offen offset:128 nt
    buffer_load_dwordx4 v[108:111], v2, s[12:15], s32 offen offset:256 nt
    s_add_u32 s32, s74, 14
    s_mul_i32 s32, s32, 3072
    s_add_u32 s32, s32, s30
    buffer_load_dwordx4 v[112:115], v2, s[8:11], s32 offen offset:0 nt
    buffer_load_dwordx4 v[116:119], v2, s[8:11], s32 offen offset:128 nt
    buffer_load_dwordx4 v[120:123], v2, s[8:11], s32 offen offset:256 nt
    buffer_load_dwordx4 v[124:127], v2, s[12:15], s32 offen offset:0 nt
    buffer_load_dwordx4 v[128:131], v2, s[12:15], s32 offen offset:128 nt
    buffer_load_dwordx4 v[132:135], v2, s[12:15], s32 offen offset:256 nt
    s_add_u32 s32, s74, 21
    s_mul_i32 s32, s32, 3072
    s_add_u32 s32, s32, s30
    buffer_load_dwordx4 v[136:139], v2, s[8:11], s32 offen offset:0 nt
    buffer_load_dwordx4 v[140:143], v2, s[8:11], s32 offen offset:128 nt
    buffer_load_dwordx4 v[144:147], v2, s[8:11], s32 offen offset:256 nt
    buffer_load_dwordx4 v[148:151], v2, s[12:15], s32 offen offset:0 nt
    buffer_load_dwordx4 v[152:155], v2, s[12:15], s32 offen offset:128 nt
    buffer_load_dwordx4 v[156:159], v2, s[12:15], s32 offen offset:256 nt
    s_add_u32 s32, s74, 28
    s_mul_i32 s32, s32, 3072
    s_add_u32 s32, s32, s30
    buffer_load_dwordx4 v[160:163], v2, s[8:11], s32 offen offset:0 nt
    buffer_load_dwordx4 v[164:167], v2, s[8:11], s32 offen offset:128 nt
    buffer_load_dwordx4 v[168:171], v2, s[8:11], s32 offen offset:256 nt
    buffer_load_dwordx4 v[172:175], v2, s[12:15], s32 offen offset:0 nt
    buffer_load_dwordx4 v[176:179], v2, s[12:15], s32 offen offset:128 nt
    buffer_load_dwordx4 v[180:183], v2, s[12:15], s32 offen offset:256 nt
    s_add_u32 s32, s74, 35
    s_mul_i32 s32, s32, 3072
    s_add_u32 s32, s32, s30
    buffer_load_dwordx4 v[184:187], v2, s[8:11], s32 offen offset:0 nt
    buffer_load_dwordx4 v[188:191], v2, s[8:11], s32 offen offset:128 nt
    buffer_load_dwordx4 v[192:195], v2, s[8:11], s32 offen offset:256 nt
    buffer_load_dwordx4 v[196:199], v2, s[12:15], s32 offen offset:0 nt
    buffer_load_dwordx4 v[200:203], v2, s[12:15], s32 offen offset:128 nt
    buffer_load_dwordx4 v[204:207], v2, s[12:15], s32 offen offset:256 nt
    s_add_u32 s32, s74, 42
    s_mul_i32 s32, s32, 3072
    s_add_u32 s32, s32, s30
    buffer_load_dwordx4 v[208:211], v2, s[8:11], s32 offen offset:0 nt
    buffer_load_dwordx4 v[212:215], v2, s[8:11], s32 offen offset:128 nt
    buffer_load_dwordx4 v[216:219], v2, s[8:11], s32 offen offset:256 nt
    buffer_load_dwordx4 v[220:223], v2, s[12:15], s32 offen offset:0 nt
    buffer_load_dwordx4 v[224:227], v2, s[12:15], s32 offen offset:128 nt
    buffer_load_dwordx4 v[228:231], v2, s[12:15], s32 offen offset:256 nt
    s_add_u32 s32, s74, 49
    s_mul_i32 s32, s32, 3072
    s_add_u32 s32, s32, s30
    buffer_load_dwordx4 v[232:235], v2, s[8:11], s32 offen offset:0 nt
    buffer_load_dwordx4 v[236:239], v2, s[8:11], s32 offen offset:128 nt
    buffer_load_dwordx4 v[240:243], v2, s[8:11], s32 offen offset:256 nt
    buffer_load_dwordx4 v[244:247], v2, s[12:15], s32 offen offset:0 nt
    buffer_load_dwordx4 v[248:251], v2, s[12:15], s32 offen offset:128 nt
    buffer_load_dwordx4 v[252:255], v2, s[12:15], s32 offen offset:256 nt
L_noffn2:
    s_mul_i32 s33, s3, 3136
    s_add_u32 s33, s33, 0
    v_lshlrev_b32 v54, 4, v1
    v_add_u32 v54, s33, v54
    v_mov_b32 v58, 0
    v_mov_b32 v59, 0
    v_mov_b32 v60, 0
    v_mov_b32 v61, 0
    ds_write_b128 v54, v[58:61] offset:0
    ds_write_b128 v54, v[58:61] offset:1024
    ds_write_b128 v54, v[58:61] offset:2048
    s_mov_b64 exec, 0xf
    ds_write_b128 v54, v[58:61] offset:3072
    v_mul_u32_u24 v55, 784, v1
    v_add_u32 v55, s33, v55
    v_mov_b32 v56, 0xf149f2ca
    ds_write_b32 v55, v56 offset:768
    s_mov_b64 exec, -1
    s_mov_b32 s31, 0
    s_mul_i32 s33, s31, 384
    v_add_u32 v54, s33, v15
    ds_read_b128 v[16:19], v54 offset:0
    ds_read_b128 v[20:23], v54 offset:128
    ds_read_b128 v[24:27], v54 offset:256
    v_mov_b32 v28, 0
    v_mov_b32 v29, 0
    v_mov_b32 v30, 0
    v_mov_b32 v31, 0
    v_mov_b32 v32, 0
    v_mov_b32 v33, 0
    v_mov_b32 v34, 0
    v_mov_b32 v35, 0
    v_mov_b32 v36, 0
    v_mov_b32 v37, 0
    v_mov_b32 v38, 0
    v_mov_b32 v39, 0
    v_mov_b32 v40, 0
    v_mov_b32 v41, 0
    v_mov_b32 v42, 0
    v_mov_b32 v43, 0
    v_mov_b32 v44, 0
    v_mov_b32 v45, 0
    v_mov_b32 v46, 0
    v_mov_b32 v47, 0
    v_mov_b32 v48, 0
    v_mov_b32 v49, 0
    v_mov_b32 v50, 0
    v_mov_b32 v51, 0
    v_mov_b32 v52, 0xf149f2ca
    v_mov_b32 v53, 0
    s_mov_b32 s40, 0x3d93cd3a
    s_mov_b32 s41, 0x3fb8aa3b
    s_waitcnt lgkmcnt(0)
    s_cmp_eq_u32 s3, 7
    s_cbranch_scc1 L_srv0
    s_mov_b64 exec, 1
    ds_add_rtn_u32 v6, v5, v4
    s_mov_b64 exec, -1
    s_waitcnt vmcnt(45)
    v_dot2_f32_bf16 v54, v64, v16, 0
    v_dot2_f32_bf16 v55, v68, v20, 0
    v_dot2_f32_bf16 v56, v72, v24, 0
    s_waitcnt lgkmcnt(0)
    v_readfirstlane_b32 s33, v6
    s_lshl_b32 s33, s33, 2
    s_add_u32 s33, s33, 139536
    v_mov_b32 v7, s33
    ds_read_b32 v6, v7
    v_dot2c_f32_bf16 v54, v65, v17
    v_dot2c_f32_bf16 v55, v69, v21
    v_dot2c_f32_bf16 v56, v73, v25
    v_dot2c_f32_bf16 v54, v66, v18
    v_dot2c_f32_bf16 v55, v70, v22
    v_dot2c_f32_bf16 v56, v74, v26
    v_dot2c_f32_bf16 v54, v67, v19
    v_dot2c_f32_bf16 v55, v71, v23
    v_dot2c_f32_bf16 v56, v75, v27
    s_waitcnt lgkmcnt(0)
    v_readfirstlane_b32 s70, v6
    s_cmp_eq_u32 s70, -1
    s_cbranch_scc1 L_twi0
L_twreti0:
    s_lshr_b32 s34, s70, 10
    s_and_b32 s35, s70, 1023
    s_mul_i32 s34, s34, 100663296
    s_mul_i32 s35, s35, 3072
    s_add_u32 s32, s34, s35
    s_add_u32 s32, s32, s30
    s_cmp_lt_u32 s70, 4096
    s_cselect_b32 s32, s32, 0
    s_cselect_b32 s10, s10, 0
    s_cselect_b32 s14, s14, 0
    buffer_load_dwordx4 v[64:67], v2, s[8:11], s32 offen offset:0 nt
    buffer_load_dwordx4 v[68:71], v2, s[8:11], s32 offen offset:128 nt
    buffer_load_dwordx4 v[72:75], v2, s[8:11], s32 offen offset:256 nt
    v_add_f32 v54, v54, v55
    v_add_f32 v54, v54, v56
    s_nop 1
    v_add_f32_dpp v54, v54, v54 quad_perm:[1,0,3,2] row_mask:0xf bank_mask:0xf
    s_nop 1
    v_add_f32_dpp v54, v54, v54 quad_perm:[2,3,0,1] row_mask:0xf bank_mask:0xf
    s_nop 1
    v_add_f32_dpp v54, v54, v54 row_half_mirror row_mask:0xf bank_mask:0xf
    v_cvt_pk_bf16_f32 v54, v54, v54
    v_and_b32 v54, 0xffff0000, v54
    v_mul_f32 v54, s40, v54
    v_cvt_pk_bf16_f32 v54, v54, v54
    v_and_b32 v54, 0xffff0000, v54
    v_cmp_gt_f32 vcc, v54, v52
    s_cbranch_vccnz L_rsi0
L_rsreti0:
    v_sub_f32 v55, v54, v52
    v_mul_f32 v55, s41, v55
    v_exp_f32 v55, v55
    s_nop 0
    v_add_f32 v53, v53, v55
    v_cvt_pk_bf16_f32 v57, v55, 0
    v_cvt_pk_bf16_f32 v58, 0, v55
    s_waitcnt vmcnt(45)
    v_dot2c_f32_bf16 v28, v76, v57
    v_dot2c_f32_bf16 v29, v76, v58
    v_dot2c_f32_bf16 v30, v77, v57
    v_dot2c_f32_bf16 v31, v77, v58
    v_dot2c_f32_bf16 v32, v78, v57
    v_dot2c_f32_bf16 v33, v78, v58
    v_dot2c_f32_bf16 v34, v79, v57
    v_dot2c_f32_bf16 v35, v79, v58
    v_dot2c_f32_bf16 v36, v80, v57
    v_dot2c_f32_bf16 v37, v80, v58
    v_dot2c_f32_bf16 v38, v81, v57
    v_dot2c_f32_bf16 v39, v81, v58
    v_dot2c_f32_bf16 v40, v82, v57
    v_dot2c_f32_bf16 v41, v82, v58
    v_dot2c_f32_bf16 v42, v83, v57
    v_dot2c_f32_bf16 v43, v83, v58
    v_dot2c_f32_bf16 v44, v84, v57
    v_dot2c_f32_bf16 v45, v84, v58
    v_dot2c_f32_bf16 v46, v85, v57
    v_dot2c_f32_bf16 v47, v85, v58
    v_dot2c_f32_bf16 v48, v86, v57
    v_dot2c_f32_bf16 v49, v86, v58
    v_dot2c_f32_bf16 v50, v87, v57
    v_dot2c_f32_bf16 v51, v87, v58
    buffer_load_dwordx4 v[76:79], v2, s[12:15], s32 offen offset:0 nt
    buffer_load_dwordx4 v[80:83], v2, s[12:15], s32 offen offset:128 nt
    buffer_load_dwordx4 v[84:87], v2, s[12:15], s32 offen offset:256 nt
    s_mov_b64 exec, 1
    ds_add_rtn_u32 v6, v5, v4
    s_mov_b64 exec, -1
    s_waitcnt vmcnt(45)
    v_dot2_f32_bf16 v54, v88, v16, 0
    v_dot2_f32_bf16 v55, v92, v20, 0
    v_dot2_f32_bf16 v56, v96, v24, 0
    s_waitcnt lgkmcnt(0)
    v_readfirstlane_b32 s33, v6
    s_lshl_b32 s33, s33, 2
    s_add_u32 s33, s33, 139536
    v_mov_b32 v7, s33
    ds_read_b32 v6, v7
    v_dot2c_f32_bf16 v54, v89, v17
    v_dot2c_f32_bf16 v55, v93, v21
    v_dot2c_f32_bf16 v56, v97, v25
    v_dot2c_f32_bf16 v54, v90, v18
    v_dot2c_f32_bf16 v55, v94, v22
    v_dot2c_f32_bf16 v56, v98, v26
    v_dot2c_f32_bf16 v54, v91, v19
    v_dot2c_f32_bf16 v55, v95, v23
    v_dot2c_f32_bf16 v56, v99, v27
    s_waitcnt lgkmcnt(0)
    v_readfirstlane_b32 s71, v6
    s_cmp_eq_u32 s71, -1
    s_cbranch_scc1 L_twi1
L_twreti1:
    s_lshr_b32 s34, s71, 10
    s_and_b32 s35, s71, 1023
    s_mul_i32 s34, s34, 100663296
    s_mul_i32 s35, s35, 3072
    s_add_u32 s32, s34, s35
    s_add_u32 s32, s32, s30
    s_cmp_lt_u32 s71, 4096
    s_cselect_b32 s32, s32, 0
    s_cselect_b32 s10, s10, 0
    s_cselect_b32 s14, s14, 0
    buffer_load_dwordx4 v[88:91], v2, s[8:11], s32 offen offset:0 nt
    buffer_load_dwordx4 v[92:95], v2, s[8:11], s32 offen offset:128 nt
    buffer_load_dwordx4 v[96:99], v2, s[8:11], s32 offen offset:256 nt
    v_add_f32 v54, v54, v55
    v_add_f32 v54, v54, v56
    s_nop 1
    v_add_f32_dpp v54, v54, v54 quad_perm:[1,0,3,2] row_mask:0xf bank_mask:0xf
    s_nop 1
    v_add_f32_dpp v54, v54, v54 quad_perm:[2,3,0,1] row_mask:0xf bank_mask:0xf
    s_nop 1
    v_add_f32_dpp v54, v54, v54 row_half_mirror row_mask:0xf bank_mask:0xf
    v_cvt_pk_bf16_f32 v54, v54, v54
    v_and_b32 v54, 0xffff0000, v54
    v_mul_f32 v54, s40, v54
    v_cvt_pk_bf16_f32 v54, v54, v54
    v_and_b32 v54, 0xffff0000, v54
    v_cmp_gt_f32 vcc, v54, v52
    s_cbranch_vccnz L_rsi1
L_rsreti1:
    v_sub_f32 v55, v54, v52
    v_mul_f32 v55, s41, v55
    v_exp_f32 v55, v55
    s_nop 0
    v_add_f32 v53, v53, v55
    v_cvt_pk_bf16_f32 v57, v55, 0
    v_cvt_pk_bf16_f32 v58, 0, v55
    s_waitcnt vmcnt(45)
    v_dot2c_f32_bf16 v28, v100, v57
    v_dot2c_f32_bf16 v29, v100, v58
    v_dot2c_f32_bf16 v30, v101, v57
    v_dot2c_f32_bf16 v31, v101, v58
    v_dot2c_f32_bf16 v32, v102, v57
    v_dot2c_f32_bf16 v33, v102, v58
    v_dot2c_f32_bf16 v34, v103, v57
    v_dot2c_f32_bf16 v35, v103, v58
    v_dot2c_f32_bf16 v36, v104, v57
    v_dot2c_f32_bf16 v37, v104, v58
    v_dot2c_f32_bf16 v38, v105, v57
    v_dot2c_f32_bf16 v39, v105, v58
    v_dot2c_f32_bf16 v40, v106, v57
    v_dot2c_f32_bf16 v41, v106, v58
    v_dot2c_f32_bf16 v42, v107, v57
    v_dot2c_f32_bf16 v43, v107, v58
    v_dot2c_f32_bf16 v44, v108, v57
    v_dot2c_f32_bf16 v45, v108, v58
    v_dot2c_f32_bf16 v46, v109, v57
    v_dot2c_f32_bf16 v47, v109, v58
    v_dot2c_f32_bf16 v48, v110, v57
    v_dot2c_f32_bf16 v49, v110, v58
    v_dot2c_f32_bf16 v50, v111, v57
    v_dot2c_f32_bf16 v51, v111, v58
    buffer_load_dwordx4 v[100:103], v2, s[12:15], s32 offen offset:0 nt
    buffer_load_dwordx4 v[104:107], v2, s[12:15], s32 offen offset:128 nt
    buffer_load_dwordx4 v[108:111], v2, s[12:15], s32 offen offset:256 nt
    s_waitcnt vmcnt(45)
    v_dot2_f32_bf16 v54, v112, v16, 0
    v_dot2_f32_bf16 v55, v116, v20, 0
    v_dot2_f32_bf16 v56, v120, v24, 0
    s_nop 0
    v_dot2c_f32_bf16 v54, v113, v17
    v_dot2c_f32_bf16 v55, v117, v21
    v_dot2c_f32_bf16 v56, v121, v25
    v_dot2c_f32_bf16 v54, v114, v18
    v_dot2c_f32_bf16 v55, v118, v22
    v_dot2c_f32_bf16 v56, v122, v26
    v_dot2c_f32_bf16 v54, v115, v19
    v_dot2c_f32_bf16 v55, v119, v23
    v_dot2c_f32_bf16 v56, v123, v27
    s_nop 1
    v_add_f32 v54, v54, v55
    v_add_f32 v54, v54, v56
    s_nop 1
    v_add_f32_dpp v54, v54, v54 quad_perm:[1,0,3,2] row_mask:0xf bank_mask:0xf
    s_nop 1
    v_add_f32_dpp v54, v54, v54 quad_perm:[2,3,0,1] row_mask:0xf bank_mask:0xf
    s_nop 1
    v_add_f32_dpp v54, v54, v54 row_half_mirror row_mask:0xf bank_mask:0xf
    v_cvt_pk_bf16_f32 v54, v54, v54
    v_and_b32 v54, 0xffff0000, v54
    v_mul_f32 v54, s40, v54
    v_cvt_pk_bf16_f32 v54, v54, v54
    v_and_b32 v54, 0xffff0000, v54
    v_cmp_gt_f32 vcc, v54, v52
    s_cbranch_vccnz L_rss0
L_rsrets0:
    v_sub_f32 v55, v54, v52
    v_mul_f32 v55, s41, v55
    v_exp_f32 v55, v55
    s_nop 0
    v_add_f32 v53, v53, v55
    v_cvt_pk_bf16_f32 v57, v55, 0
    v_cvt_pk_bf16_f32 v58, 0, v55
    s_waitcnt vmcnt(42)
    v_dot2c_f32_bf16 v28, v124, v57
    v_dot2c_f32_bf16 v29, v124, v58
    v_dot2c_f32_bf16 v30, v125, v57
    v_dot2c_f32_bf16 v31, v125, v58
    v_dot2c_f32_bf16 v32, v126, v57
    v_dot2c_f32_bf16 v33, v126, v58
    v_dot2c_f32_bf16 v34, v127, v57
    v_dot2c_f32_bf16 v35, v127, v58
    v_dot2c_f32_bf16 v36, v128, v57
    v_dot2c_f32_bf16 v37, v128, v58
    v_dot2c_f32_bf16 v38, v129, v57
    v_dot2c_f32_bf16 v39, v129, v58
    v_dot2c_f32_bf16 v40, v130, v57
    v_dot2c_f32_bf16 v41, v130, v58
    v_dot2c_f32_bf16 v42, v131, v57
    v_dot2c_f32_bf16 v43, v131, v58
    v_dot2c_f32_bf16 v44, v132, v57
    v_dot2c_f32_bf16 v45, v132, v58
    v_dot2c_f32_bf16 v46, v133, v57
    v_dot2c_f32_bf16 v47, v133, v58
    v_dot2c_f32_bf16 v48, v134, v57
    v_dot2c_f32_bf16 v49, v134, v58
    v_dot2c_f32_bf16 v50, v135, v57
    v_dot2c_f32_bf16 v51, v135, v58
    s_waitcnt vmcnt(39)
    v_dot2_f32_bf16 v54, v136, v16, 0
    v_dot2_f32_bf16 v55, v140, v20, 0
    v_dot2_f32_bf16 v56, v144, v24, 0
    s_nop 0
    v_dot2c_f32_bf16 v54, v137, v17
    v_dot2c_f32_bf16 v55, v141, v21
    v_dot2c_f32_bf16 v56, v145, v25
    v_dot2c_f32_bf16 v54, v138, v18
    v_dot2c_f32_bf16 v55, v142, v22
    v_dot2c_f32_bf16 v56, v146, v26
    v_dot2c_f32_bf16 v54, v139, v19
    v_dot2c_f32_bf16 v55, v143, v23
    v_dot2c_f32_bf16 v56, v147, v27
    s_nop 1
    v_add_f32 v54, v54, v55
    v_add_f32 v54, v54, v56
    s_nop 1
    v_add_f32_dpp v54, v54, v54 quad_perm:[1,0,3,2] row_mask:0xf bank_mask:0xf
    s_nop 1
    v_add_f32_dpp v54, v54, v54 quad_perm:[2,3,0,1] row_mask:0xf bank_mask:0xf
    s_nop 1
    v_add_f32_dpp v54, v54, v54 row_half_mirror row_mask:0xf bank_mask:0xf
    v_cvt_pk_bf16_f32 v54, v54, v54
    v_and_b32 v54, 0xffff0000, v54
    v_mul_f32 v54, s40, v54
    v_cvt_pk_bf16_f32 v54, v54, v54
    v_and_b32 v54, 0xffff0000, v54
    v_cmp_gt_f32 vcc, v54, v52
    s_cbranch_vccnz L_rss1
L_rsrets1:
    v_sub_f32 v55, v54, v52
    v_mul_f32 v55, s41, v55
    v_exp_f32 v55, v55
    s_nop 0
    v_add_f32 v53, v53, v55
    v_cvt_pk_bf16_f32 v57, v55, 0
    v_cvt_pk_bf16_f32 v58, 0, v55
    s_waitcnt vmcnt(36)
    v_dot2c_f32_bf16 v28, v148, v57
    v_dot2c_f32_bf16 v29, v148, v58
    v_dot2c_f32_bf16 v30, v149, v57
    v_dot2c_f32_bf16 v31, v149, v58
    v_dot2c_f32_bf16 v32, v150, v57
    v_dot2c_f32_bf16 v33, v150, v58
    v_dot2c_f32_bf16 v34, v151, v57
    v_dot2c_f32_bf16 v35, v151, v58
    v_dot2c_f32_bf16 v36, v152, v57
    v_dot2c_f32_bf16 v37, v152, v58
    v_dot2c_f32_bf16 v38, v153, v57
    v_dot2c_f32_bf16 v39, v153, v58
    v_dot2c_f32_bf16 v40, v154, v57
    v_dot2c_f32_bf16 v41, v154, v58
    v_dot2c_f32_bf16 v42, v155, v57
    v_dot2c_f32_bf16 v43, v155, v58
    v_dot2c_f32_bf16 v44, v156, v57
    v_dot2c_f32_bf16 v45, v156, v58
    v_dot2c_f32_bf16 v46, v157, v57
    v_dot2c_f32_bf16 v47, v157, v58
    v_dot2c_f32_bf16 v48, v158, v57
    v_dot2c_f32_bf16 v49, v158, v58
    v_dot2c_f32_bf16 v50, v159, v57
    v_dot2c_f32_bf16 v51, v159, v58
    s_waitcnt vmcnt(33)
    v_dot2_f32_bf16 v54, v160, v16, 0
    v_dot2_f32_bf16 v55, v164, v20, 0
    v_dot2_f32_bf16 v56, v168, v24, 0
    s_nop 0
    v_dot2c_f32_bf16 v54, v161, v17
    v_dot2c_f32_bf16 v55, v165, v21
    v_dot2c_f32_bf16 v56, v169, v25
    v_dot2c_f32_bf16 v54, v162, v18
    v_dot2c_f32_bf16 v55, v166, v22
    v_dot2c_f32_bf16 v56, v170, v26
    v_dot2c_f32_bf16 v54, v163, v19
    v_dot2c_f32_bf16 v55, v167, v23
    v_dot2c_f32_bf16 v56, v171, v27
    s_nop 1
    v_add_f32 v54, v54, v55
    v_add_f32 v54, v54, v56
    s_nop 1
    v_add_f32_dpp v54, v54, v54 quad_perm:[1,0,3,2] row_mask:0xf bank_mask:0xf
    s_nop 1
    v_add_f32_dpp v54, v54, v54 quad_perm:[2,3,0,1] row_mask:0xf bank_mask:0xf
    s_nop 1
    v_add_f32_dpp v54, v54, v54 row_half_mirror row_mask:0xf bank_mask:0xf
    v_cvt_pk_bf16_f32 v54, v54, v54
    v_and_b32 v54, 0xffff0000, v54
    v_mul_f32 v54, s40, v54
    v_cvt_pk_bf16_f32 v54, v54, v54
    v_and_b32 v54, 0xffff0000, v54
    v_cmp_gt_f32 vcc, v54, v52
    s_cbranch_vccnz L_rss2
L_rsrets2:
    v_sub_f32 v55, v54, v52
    v_mul_f32 v55, s41, v55
    v_exp_f32 v55, v55
    s_nop 0
    v_add_f32 v53, v53, v55
    v_cvt_pk_bf16_f32 v57, v55, 0
    v_cvt_pk_bf16_f32 v58, 0, v55
    s_waitcnt vmcnt(30)
    v_dot2c_f32_bf16 v28, v172, v57
    v_dot2c_f32_bf16 v29, v172, v58
    v_dot2c_f32_bf16 v30, v173, v57
    v_dot2c_f32_bf16 v31, v173, v58
    v_dot2c_f32_bf16 v32, v174, v57
    v_dot2c_f32_bf16 v33, v174, v58
    v_dot2c_f32_bf16 v34, v175, v57
    v_dot2c_f32_bf16 v35, v175, v58
    v_dot2c_f32_bf16 v36, v176, v57
    v_dot2c_f32_bf16 v37, v176, v58
    v_dot2c_f32_bf16 v38, v177, v57
    v_dot2c_f32_bf16 v39, v177, v58
    v_dot2c_f32_bf16 v40, v178, v57
    v_dot2c_f32_bf16 v41, v178, v58
    v_dot2c_f32_bf16 v42, v179, v57
    v_dot2c_f32_bf16 v43, v179, v58
    v_dot2c_f32_bf16 v44, v180, v57
    v_dot2c_f32_bf16 v45, v180, v58
    v_dot2c_f32_bf16 v46, v181, v57
    v_dot2c_f32_bf16 v47, v181, v58
    v_dot2c_f32_bf16 v48, v182, v57
    v_dot2c_f32_bf16 v49, v182, v58
    v_dot2c_f32_bf16 v50, v183, v57
    v_dot2c_f32_bf16 v51, v183, v58
    s_waitcnt vmcnt(27)
    v_dot2_f32_bf16 v54, v184, v16, 0
    v_dot2_f32_bf16 v55, v188, v20, 0
    v_dot2_f32_bf16 v56, v192, v24, 0
    s_nop 0
    v_dot2c_f32_bf16 v54, v185, v17
    v_dot2c_f32_bf16 v55, v189, v21
    v_dot2c_f32_bf16 v56, v193, v25
    v_dot2c_f32_bf16 v54, v186, v18
    v_dot2c_f32_bf16 v55, v190, v22
    v_dot2c_f32_bf16 v56, v194, v26
    v_dot2c_f32_bf16 v54, v187, v19
    v_dot2c_f32_bf16 v55, v191, v23
    v_dot2c_f32_bf16 v56, v195, v27
    s_nop 1
    v_add_f32 v54, v54, v55
    v_add_f32 v54, v54, v56
    s_nop 1
    v_add_f32_dpp v54, v54, v54 quad_perm:[1,0,3,2] row_mask:0xf bank_mask:0xf
    s_nop 1
    v_add_f32_dpp v54, v54, v54 quad_perm:[2,3,0,1] row_mask:0xf bank_mask:0xf
    s_nop 1
    v_add_f32_dpp v54, v54, v54 row_half_mirror row_mask:0xf bank_mask:0xf
    v_cvt_pk_bf16_f32 v54, v54, v54
    v_and_b32 v54, 0xffff0000, v54
    v_mul_f32 v54, s40, v54
    v_cvt_pk_bf16_f32 v54, v54, v54
    v_and_b32 v54, 0xffff0000, v54
    v_cmp_gt_f32 vcc, v54, v52
    s_cbranch_vccnz L_rss3
L_rsrets3:
    v_sub_f32 v55, v54, v52
    v_mul_f32 v55, s41, v55
    v_exp_f32 v55, v55
    s_nop 0
    v_add_f32 v53, v53, v55
    v_cvt_pk_bf16_f32 v57, v55, 0
    v_cvt_pk_bf16_f32 v58, 0, v55
    s_waitcnt vmcnt(24)
    v_dot2c_f32_bf16 v28, v196, v57
    v_dot2c_f32_bf16 v29, v196, v58
    v_dot2c_f32_bf16 v30, v197, v57
    v_dot2c_f32_bf16 v31, v197, v58
    v_dot2c_f32_bf16 v32, v198, v57
    v_dot2c_f32_bf16 v33, v198, v58
    v_dot2c_f32_bf16 v34, v199, v57
    v_dot2c_f32_bf16 v35, v199, v58
    v_dot2c_f32_bf16 v36, v200, v57
    v_dot2c_f32_bf16 v37, v200, v58
    v_dot2c_f32_bf16 v38, v201, v57
    v_dot2c_f32_bf16 v39, v201, v58
    v_dot2c_f32_bf16 v40, v202, v57
    v_dot2c_f32_bf16 v41, v202, v58
    v_dot2c_f32_bf16 v42, v203, v57
    v_dot2c_f32_bf16 v43, v203, v58
    v_dot2c_f32_bf16 v44, v204, v57
    v_dot2c_f32_bf16 v45, v204, v58
    v_dot2c_f32_bf16 v46, v205, v57
    v_dot2c_f32_bf16 v47, v205, v58
    v_dot2c_f32_bf16 v48, v206, v57
    v_dot2c_f32_bf16 v49, v206, v58
    v_dot2c_f32_bf16 v50, v207, v57
    v_dot2c_f32_bf16 v51, v207, v58
    s_waitcnt vmcnt(21)
    v_dot2_f32_bf16 v54, v208, v16, 0
    v_dot2_f32_bf16 v55, v212, v20, 0
    v_dot2_f32_bf16 v56, v216, v24, 0
    s_nop 0
    v_dot2c_f32_bf16 v54, v209, v17
    v_dot2c_f32_bf16 v55, v213, v21
    v_dot2c_f32_bf16 v56, v217, v25
    v_dot2c_f32_bf16 v54, v210, v18
    v_dot2c_f32_bf16 v55, v214, v22
    v_dot2c_f32_bf16 v56, v218, v26
    v_dot2c_f32_bf16 v54, v211, v19
    v_dot2c_f32_bf16 v55, v215, v23
    v_dot2c_f32_bf16 v56, v219, v27
    s_nop 1
    v_add_f32 v54, v54, v55
    v_add_f32 v54, v54, v56
    s_nop 1
    v_add_f32_dpp v54, v54, v54 quad_perm:[1,0,3,2] row_mask:0xf bank_mask:0xf
    s_nop 1
    v_add_f32_dpp v54, v54, v54 quad_perm:[2,3,0,1] row_mask:0xf bank_mask:0xf
    s_nop 1
    v_add_f32_dpp v54, v54, v54 row_half_mirror row_mask:0xf bank_mask:0xf
    v_cvt_pk_bf16_f32 v54, v54, v54
    v_and_b32 v54, 0xffff0000, v54
    v_mul_f32 v54, s40, v54
    v_cvt_pk_bf16_f32 v54, v54, v54
    v_and_b32 v54, 0xffff0000, v54
    v_cmp_gt_f32 vcc, v54, v52
    s_cbranch_vccnz L_rss4
L_rsrets4:
    v_sub_f32 v55, v54, v52
    v_mul_f32 v55, s41, v55
    v_exp_f32 v55, v55
    s_nop 0
    v_add_f32 v53, v53, v55
    v_cvt_pk_bf16_f32 v57, v55, 0
    v_cvt_pk_bf16_f32 v58, 0, v55
    s_waitcnt vmcnt(18)
    v_dot2c_f32_bf16 v28, v220, v57
    v_dot2c_f32_bf16 v29, v220, v58
    v_dot2c_f32_bf16 v30, v221, v57
    v_dot2c_f32_bf16 v31, v221, v58
    v_dot2c_f32_bf16 v32, v222, v57
    v_dot2c_f32_bf16 v33, v222, v58
    v_dot2c_f32_bf16 v34, v223, v57
    v_dot2c_f32_bf16 v35, v223, v58
    v_dot2c_f32_bf16 v36, v224, v57
    v_dot2c_f32_bf16 v37, v224, v58
    v_dot2c_f32_bf16 v38, v225, v57
    v_dot2c_f32_bf16 v39, v225, v58
    v_dot2c_f32_bf16 v40, v226, v57
    v_dot2c_f32_bf16 v41, v226, v58
    v_dot2c_f32_bf16 v42, v227, v57
    v_dot2c_f32_bf16 v43, v227, v58
    v_dot2c_f32_bf16 v44, v228, v57
    v_dot2c_f32_bf16 v45, v228, v58
    v_dot2c_f32_bf16 v46, v229, v57
    v_dot2c_f32_bf16 v47, v229, v58
    v_dot2c_f32_bf16 v48, v230, v57
    v_dot2c_f32_bf16 v49, v230, v58
    v_dot2c_f32_bf16 v50, v231, v57
    v_dot2c_f32_bf16 v51, v231, v58
    s_waitcnt vmcnt(15)
    v_dot2_f32_bf16 v54, v232, v16, 0
    v_dot2_f32_bf16 v55, v236, v20, 0
    v_dot2_f32_bf16 v56, v240, v24, 0
    s_nop 0
    v_dot2c_f32_bf16 v54, v233, v17
    v_dot2c_f32_bf16 v55, v237, v21
    v_dot2c_f32_bf16 v56, v241, v25
    v_dot2c_f32_bf16 v54, v234, v18
    v_dot2c_f32_bf16 v55, v238, v22
    v_dot2c_f32_bf16 v56, v242, v26
    v_dot2c_f32_bf16 v54, v235, v19
    v_dot2c_f32_bf16 v55, v239, v23
    v_dot2c_f32_bf16 v56, v243, v27
    s_nop 1
    v_add_f32 v54, v54, v55
    v_add_f32 v54, v54, v56
    s_nop 1
    v_add_f32_dpp v54, v54, v54 quad_perm:[1,0,3,2] row_mask:0xf bank_mask:0xf
    s_nop 1
    v_add_f32_dpp v54, v54, v54 quad_perm:[2,3,0,1] row_mask:0xf bank_mask:0xf
    s_nop 1
    v_add_f32_dpp v54, v54, v54 row_half_mirror row_mask:0xf bank_mask:0xf
    v_cvt_pk_bf16_f32 v54, v54, v54
    v_and_b32 v54, 0xffff0000, v54
    v_mul_f32 v54, s40, v54
    v_cvt_pk_bf16_f32 v54, v54, v54
    v_and_b32 v54, 0xffff0000, v54
    v_cmp_gt_f32 vcc, v54, v52
    s_cbranch_vccnz L_rss5
L_rsrets5:
    v_sub_f32 v55, v54, v52
    v_mul_f32 v55, s41, v55
    v_exp_f32 v55, v55
    s_nop 0
    v_add_f32 v53, v53, v55
    v_cvt_pk_bf16_f32 v57, v55, 0
    v_cvt_pk_bf16_f32 v58, 0, v55
    s_waitcnt vmcnt(12)
    v_dot2c_f32_bf16 v28, v244, v57
    v_dot2c_f32_bf16 v29, v244, v58
    v_dot2c_f32_bf16 v30, v245, v57
    v_dot2c_f32_bf16 v31, v245, v58
    v_dot2c_f32_bf16 v32, v246, v57
    v_dot2c_f32_bf16 v33, v246, v58
    v_dot2c_f32_bf16 v34, v247, v57
    v_dot2c_f32_bf16 v35, v247, v58
    v_dot2c_f32_bf16 v36, v248, v57
    v_dot2c_f32_bf16 v37, v248, v58
    v_dot2c_f32_bf16 v38, v249, v57
    v_dot2c_f32_bf16 v39, v249, v58
    v_dot2c_f32_bf16 v40, v250, v57
    v_dot2c_f32_bf16 v41, v250, v58
    v_dot2c_f32_bf16 v42, v251, v57
    v_dot2c_f32_bf16 v43, v251, v58
    v_dot2c_f32_bf16 v44, v252, v57
    v_dot2c_f32_bf16 v45, v252, v58
    v_dot2c_f32_bf16 v46, v253, v57
    v_dot2c_f32_bf16 v47, v253, v58
    v_dot2c_f32_bf16 v48, v254, v57
    v_dot2c_f32_bf16 v49, v254, v58
    v_dot2c_f32_bf16 v50, v255, v57
    v_dot2c_f32_bf16 v51, v255, v58
L_loop:
    s_cmp_ge_u32 s70, 4096
    s_cbranch_scc1 L_exit
    s_lshr_b32 s33, s70, 10
    s_cmp_lg_u32 s33, s31
    s_cbranch_scc1 L_sw0
L_swret0:
    s_mov_b64 exec, 1
    ds_add_rtn_u32 v6, v5, v4
    s_mov_b64 exec, -1
    s_waitcnt vmcnt(9)
    v_dot2_f32_bf16 v54, v64, v16, 0
    v_dot2_f32_bf16 v55, v68, v20, 0
    v_dot2_f32_bf16 v56, v72, v24, 0
    s_waitcnt lgkmcnt(0)
    v_readfirstlane_b32 s33, v6
    s_lshl_b32 s33, s33, 2
    s_add_u32 s33, s33, 139536
    v_mov_b32 v7, s33
    ds_read_b32 v6, v7
    v_dot2c_f32_bf16 v54, v65, v17
    v_dot2c_f32_bf16 v55, v69, v21
    v_dot2c_f32_bf16 v56, v73, v25
    v_dot2c_f32_bf16 v54, v66, v18
    v_dot2c_f32_bf16 v55, v70, v22
    v_dot2c_f32_bf16 v56, v74, v26
    v_dot2c_f32_bf16 v54, v67, v19
    v_dot2c_f32_bf16 v55, v71, v23
    v_dot2c_f32_bf16 v56, v75, v27
    s_waitcnt lgkmcnt(0)
    v_readfirstlane_b32 s70, v6
    s_cmp_eq_u32 s70, -1
    s_cbranch_scc1 L_twm0
L_twretm0:
    s_lshr_b32 s34, s70, 10
    s_and_b32 s35, s70, 1023
    s_mul_i32 s34, s34, 100663296
    s_mul_i32 s35, s35, 3072
    s_add_u32 s32, s34, s35
    s_add_u32 s32, s32, s30
    s_cmp_lt_u32 s70, 4096
    s_cselect_b32 s32, s32, 0
    s_cselect_b32 s10, s10, 0
    s_cselect_b32 s14, s14, 0
    buffer_load_dwordx4 v[64:67], v2, s[8:11], s32 offen offset:0 nt
    buffer_load_dwordx4 v[68:71], v2, s[8:11], s32 offen offset:128 nt
    buffer_load_dwordx4 v[72:75], v2, s[8:11], s32 offen offset:256 nt
    v_add_f32 v54, v54, v55
    v_add_f32 v54, v54, v56
    s_nop 1
    v_add_f32_dpp v54, v54, v54 quad_perm:[1,0,3,2] row_mask:0xf bank_mask:0xf
    s_nop 1
    v_add_f32_dpp v54, v54, v54 quad_perm:[2,3,0,1] row_mask:0xf bank_mask:0xf
    s_nop 1
    v_add_f32_dpp v54, v54, v54 row_half_mirror row_mask:0xf bank_mask:0xf
    v_cvt_pk_bf16_f32 v54, v54, v54
    v_and_b32 v54, 0xffff0000, v54
    v_mul_f32 v54, s40, v54
    v_cvt_pk_bf16_f32 v54, v54, v54
    v_and_b32 v54, 0xffff0000, v54
    v_cmp_gt_f32 vcc, v54, v52
    s_cbranch_vccnz L_rsm0
L_rsretm0:
    v_sub_f32 v55, v54, v52
    v_mul_f32 v55, s41, v55
    v_exp_f32 v55, v55
    s_nop 0
    v_add_f32 v53, v53, v55
    v_cvt_pk_bf16_f32 v57, v55, 0
    v_cvt_pk_bf16_f32 v58, 0, v55
    s_waitcnt vmcnt(9)
    v_dot2c_f32_bf16 v28, v76, v57
    v_dot2c_f32_bf16 v29, v76, v58
    v_dot2c_f32_bf16 v30, v77, v57
    v_dot2c_f32_bf16 v31, v77, v58
    v_dot2c_f32_bf16 v32, v78, v57
    v_dot2c_f32_bf16 v33, v78, v58
    v_dot2c_f32_bf16 v34, v79, v57
    v_dot2c_f32_bf16 v35, v79, v58
    v_dot2c_f32_bf16 v36, v80, v57
    v_dot2c_f32_bf16 v37, v80, v58
    v_dot2c_f32_bf16 v38, v81, v57
    v_dot2c_f32_bf16 v39, v81, v58
    v_dot2c_f32_bf16 v40, v82, v57
    v_dot2c_f32_bf16 v41, v82, v58
    v_dot2c_f32_bf16 v42, v83, v57
    v_dot2c_f32_bf16 v43, v83, v58
    v_dot2c_f32_bf16 v44, v84, v57
    v_dot2c_f32_bf16 v45, v84, v58
    v_dot2c_f32_bf16 v46, v85, v57
    v_dot2c_f32_bf16 v47, v85, v58
    v_dot2c_f32_bf16 v48, v86, v57
    v_dot2c_f32_bf16 v49, v86, v58
    v_dot2c_f32_bf16 v50, v87, v57
    v_dot2c_f32_bf16 v51, v87, v58
    buffer_load_dwordx4 v[76:79], v2, s[12:15], s32 offen offset:0 nt
    buffer_load_dwordx4 v[80:83], v2, s[12:15], s32 offen offset:128 nt
    buffer_load_dwordx4 v[84:87], v2, s[12:15], s32 offen offset:256 nt
    s_cmp_ge_u32 s71, 4096
    s_cbranch_scc1 L_exit
    s_lshr_b32 s33, s71, 10
    s_cmp_lg_u32 s33, s31
    s_cbranch_scc1 L_sw1
L_swret1:
    s_mov_b64 exec, 1
    ds_add_rtn_u32 v6, v5, v4
    s_mov_b64 exec, -1
    s_waitcnt vmcnt(9)
    v_dot2_f32_bf16 v54, v88, v16, 0
    v_dot2_f32_bf16 v55, v92, v20, 0
    v_dot2_f32_bf16 v56, v96, v24, 0
    s_waitcnt lgkmcnt(0)
    v_readfirstlane_b32 s33, v6
    s_lshl_b32 s33, s33, 2
    s_add_u32 s33, s33, 139536
    v_mov_b32 v7, s33
    ds_read_b32 v6, v7
    v_dot2c_f32_bf16 v54, v89, v17
    v_dot2c_f32_bf16 v55, v93, v21
    v_dot2c_f32_bf16 v56, v97, v25
    v_dot2c_f32_bf16 v54, v90, v18
    v_dot2c_f32_bf16 v55, v94, v22
    v_dot2c_f32_bf16 v56, v98, v26
    v_dot2c_f32_bf16 v54, v91, v19
    v_dot2c_f32_bf16 v55, v95, v23
    v_dot2c_f32_bf16 v56, v99, v27
    s_waitcnt lgkmcnt(0)
    v_readfirstlane_b32 s71, v6
    s_cmp_eq_u32 s71, -1
    s_cbranch_scc1 L_twm1
L_twretm1:
    s_lshr_b32 s34, s71, 10
    s_and_b32 s35, s71, 1023
    s_mul_i32 s34, s34, 100663296
    s_mul_i32 s35, s35, 3072
    s_add_u32 s32, s34, s35
    s_add_u32 s32, s32, s30
    s_cmp_lt_u32 s71, 4096
    s_cselect_b32 s32, s32, 0
    s_cselect_b32 s10, s10, 0
    s_cselect_b32 s14, s14, 0
    buffer_load_dwordx4 v[88:91], v2, s[8:11], s32 offen offset:0 nt
    buffer_load_dwordx4 v[92:95], v2, s[8:11], s32 offen offset:128 nt
    buffer_load_dwordx4 v[96:99], v2, s[8:11], s32 offen offset:256 nt
    v_add_f32 v54, v54, v55
    v_add_f32 v54, v54, v56
    s_nop 1
    v_add_f32_dpp v54, v54, v54 quad_perm:[1,0,3,2] row_mask:0xf bank_mask:0xf
    s_nop 1
    v_add_f32_dpp v54, v54, v54 quad_perm:[2,3,0,1] row_mask:0xf bank_mask:0xf
    s_nop 1
    v_add_f32_dpp v54, v54, v54 row_half_mirror row_mask:0xf bank_mask:0xf
    v_cvt_pk_bf16_f32 v54, v54, v54
    v_and_b32 v54, 0xffff0000, v54
    v_mul_f32 v54, s40, v54
    v_cvt_pk_bf16_f32 v54, v54, v54
    v_and_b32 v54, 0xffff0000, v54
    v_cmp_gt_f32 vcc, v54, v52
    s_cbranch_vccnz L_rsm1
L_rsretm1:
    v_sub_f32 v55, v54, v52
    v_mul_f32 v55, s41, v55
    v_exp_f32 v55, v55
    s_nop 0
    v_add_f32 v53, v53, v55
    v_cvt_pk_bf16_f32 v57, v55, 0
    v_cvt_pk_bf16_f32 v58, 0, v55
    s_waitcnt vmcnt(9)
    v_dot2c_f32_bf16 v28, v100, v57
    v_dot2c_f32_bf16 v29, v100, v58
    v_dot2c_f32_bf16 v30, v101, v57
    v_dot2c_f32_bf16 v31, v101, v58
    v_dot2c_f32_bf16 v32, v102, v57
    v_dot2c_f32_bf16 v33, v102, v58
    v_dot2c_f32_bf16 v34, v103, v57
    v_dot2c_f32_bf16 v35, v103, v58
    v_dot2c_f32_bf16 v36, v104, v57
    v_dot2c_f32_bf16 v37, v104, v58
    v_dot2c_f32_bf16 v38, v105, v57
    v_dot2c_f32_bf16 v39, v105, v58
    v_dot2c_f32_bf16 v40, v106, v57
    v_dot2c_f32_bf16 v41, v106, v58
    v_dot2c_f32_bf16 v42, v107, v57
    v_dot2c_f32_bf16 v43, v107, v58
    v_dot2c_f32_bf16 v44, v108, v57
    v_dot2c_f32_bf16 v45, v108, v58
    v_dot2c_f32_bf16 v46, v109, v57
    v_dot2c_f32_bf16 v47, v109, v58
    v_dot2c_f32_bf16 v48, v110, v57
    v_dot2c_f32_bf16 v49, v110, v58
    v_dot2c_f32_bf16 v50, v111, v57
    v_dot2c_f32_bf16 v51, v111, v58
    buffer_load_dwordx4 v[100:103], v2, s[12:15], s32 offen offset:0 nt
    buffer_load_dwordx4 v[104:107], v2, s[12:15], s32 offen offset:128 nt
    buffer_load_dwordx4 v[108:111], v2, s[12:15], s32 offen offset:256 nt
    s_branch L_loop
L_twi0:
    s_mov_b32 s36, 0
L_twli0:
    s_sleep 1
    ds_read_b32 v6, v7
    s_waitcnt lgkmcnt(0)
    v_readfirstlane_b32 s70, v6
    s_cmp_lg_u32 s70, -1
    s_cbranch_scc1 L_twreti0
    s_add_u32 s36, s36, 1
    s_cmp_lt_u32 s36, 80000
    s_cbranch_scc1 L_twli0
    s_mov_b32 s70, 0x7fffffff
    s_branch L_twreti0
L_rsi0:
    v_max_f32 v55, v52, v54
    v_sub_f32 v56, v52, v55
    v_mul_f32 v56, s41, v56
    v_exp_f32 v56, v56
    v_mov_b32 v52, v55
    v_mul_f32 v53, v53, v56
    v_mul_f32 v28, v28, v56
    v_mul_f32 v29, v29, v56
    v_mul_f32 v30, v30, v56
    v_mul_f32 v31, v31, v56
    v_mul_f32 v32, v32, v56
    v_mul_f32 v33, v33, v56
    v_mul_f32 v34, v34, v56
    v_mul_f32 v35, v35, v56
    v_mul_f32 v36, v36, v56
    v_mul_f32 v37, v37, v56
    v_mul_f32 v38, v38, v56
    v_mul_f32 v39, v39, v56
    v_mul_f32 v40, v40, v56
    v_mul_f32 v41, v41, v56
    v_mul_f32 v42, v42, v56
    v_mul_f32 v43, v43, v56
    v_mul_f32 v44, v44, v56
    v_mul_f32 v45, v45, v56
    v_mul_f32 v46, v46, v56
    v_mul_f32 v47, v47, v56
    v_mul_f32 v48, v48, v56
    v_mul_f32 v49, v49, v56
    v_mul_f32 v50, v50, v56
    v_mul_f32 v51, v51, v56
    s_branch L_rsreti0
L_twi1:
    s_mov_b32 s36, 0
L_twli1:
    s_sleep 1
    ds_read_b32 v6, v7
    s_waitcnt lgkmcnt(0)
    v_readfirstlane_b32 s71, v6
    s_cmp_lg_u32 s71, -1
    s_cbranch_scc1 L_twreti1
    s_add_u32 s36, s36, 1
    s_cmp_lt_u32 s36, 80000
    s_cbranch_scc1 L_twli1
    s_mov_b32 s71, 0x7fffffff
    s_branch L_twreti1
L_rsi1:
    v_max_f32 v55, v52, v54
    v_sub_f32 v56, v52, v55
    v_mul_f32 v56, s41, v56
    v_exp_f32 v56, v56
    v_mov_b32 v52, v55
    v_mul_f32 v53, v53, v56
    v_mul_f32 v28, v28, v56
    v_mul_f32 v29, v29, v56
    v_mul_f32 v30, v30, v56
    v_mul_f32 v31, v31, v56
    v_mul_f32 v32, v32, v56
    v_mul_f32 v33, v33, v56
    v_mul_f32 v34, v34, v56
    v_mul_f32 v35, v35, v56
    v_mul_f32 v36, v36, v56
    v_mul_f32 v37, v37, v56
    v_mul_f32 v38, v38, v56
    v_mul_f32 v39, v39, v56
    v_mul_f32 v40, v40, v56
    v_mul_f32 v41, v41, v56
    v_mul_f32 v42, v42, v56
    v_mul_f32 v43, v43, v56
    v_mul_f32 v44, v44, v56
    v_mul_f32 v45, v45, v56
    v_mul_f32 v46, v46, v56
    v_mul_f32 v47, v47, v56
    v_mul_f32 v48, v48, v56
    v_mul_f32 v49, v49, v56
    v_mul_f32 v50, v50, v56
    v_mul_f32 v51, v51, v56
    s_branch L_rsreti1
L_rss0:
    v_max_f32 v55, v52, v54
    v_sub_f32 v56, v52, v55
    v_mul_f32 v56, s41, v56
    v_exp_f32 v56, v56
    v_mov_b32 v52, v55
    v_mul_f32 v53, v53, v56
    v_mul_f32 v28, v28, v56
    v_mul_f32 v29, v29, v56
    v_mul_f32 v30, v30, v56
    v_mul_f32 v31, v31, v56
    v_mul_f32 v32, v32, v56
    v_mul_f32 v33, v33, v56
    v_mul_f32 v34, v34, v56
    v_mul_f32 v35, v35, v56
    v_mul_f32 v36, v36, v56
    v_mul_f32 v37, v37, v56
    v_mul_f32 v38, v38, v56
    v_mul_f32 v39, v39, v56
    v_mul_f32 v40, v40, v56
    v_mul_f32 v41, v41, v56
    v_mul_f32 v42, v42, v56
    v_mul_f32 v43, v43, v56
    v_mul_f32 v44, v44, v56
    v_mul_f32 v45, v45, v56
    v_mul_f32 v46, v46, v56
    v_mul_f32 v47, v47, v56
    v_mul_f32 v48, v48, v56
    v_mul_f32 v49, v49, v56
    v_mul_f32 v50, v50, v56
    v_mul_f32 v51, v51, v56
    s_branch L_rsrets0
L_rss1:
    v_max_f32 v55, v52, v54
    v_sub_f32 v56, v52, v55
    v_mul_f32 v56, s41, v56
    v_exp_f32 v56, v56
    v_mov_b32 v52, v55
    v_mul_f32 v53, v53, v56
    v_mul_f32 v28, v28, v56
    v_mul_f32 v29, v29, v56
    v_mul_f32 v30, v30, v56
    v_mul_f32 v31, v31, v56
    v_mul_f32 v32, v32, v56
    v_mul_f32 v33, v33, v56
    v_mul_f32 v34, v34, v56
    v_mul_f32 v35, v35, v56
    v_mul_f32 v36, v36, v56
    v_mul_f32 v37, v37, v56
    v_mul_f32 v38, v38, v56
    v_mul_f32 v39, v39, v56
    v_mul_f32 v40, v40, v56
    v_mul_f32 v41, v41, v56
    v_mul_f32 v42, v42, v56
    v_mul_f32 v43, v43, v56
    v_mul_f32 v44, v44, v56
    v_mul_f32 v45, v45, v56
    v_mul_f32 v46, v46, v56
    v_mul_f32 v47, v47, v56
    v_mul_f32 v48, v48, v56
    v_mul_f32 v49, v49, v56
    v_mul_f32 v50, v50, v56
    v_mul_f32 v51, v51, v56
    s_branch L_rsrets1
L_rss2:
    v_max_f32 v55, v52, v54
    v_sub_f32 v56, v52, v55
    v_mul_f32 v56, s41, v56
    v_exp_f32 v56, v56
    v_mov_b32 v52, v55
    v_mul_f32 v53, v53, v56
    v_mul_f32 v28, v28, v56
    v_mul_f32 v29, v29, v56
    v_mul_f32 v30, v30, v56
    v_mul_f32 v31, v31, v56
    v_mul_f32 v32, v32, v56
    v_mul_f32 v33, v33, v56
    v_mul_f32 v34, v34, v56
    v_mul_f32 v35, v35, v56
    v_mul_f32 v36, v36, v56
    v_mul_f32 v37, v37, v56
    v_mul_f32 v38, v38, v56
    v_mul_f32 v39, v39, v56
    v_mul_f32 v40, v40, v56
    v_mul_f32 v41, v41, v56
    v_mul_f32 v42, v42, v56
    v_mul_f32 v43, v43, v56
    v_mul_f32 v44, v44, v56
    v_mul_f32 v45, v45, v56
    v_mul_f32 v46, v46, v56
    v_mul_f32 v47, v47, v56
    v_mul_f32 v48, v48, v56
    v_mul_f32 v49, v49, v56
    v_mul_f32 v50, v50, v56
    v_mul_f32 v51, v51, v56
    s_branch L_rsrets2
L_rss3:
    v_max_f32 v55, v52, v54
    v_sub_f32 v56, v52, v55
    v_mul_f32 v56, s41, v56
    v_exp_f32 v56, v56
    v_mov_b32 v52, v55
    v_mul_f32 v53, v53, v56
    v_mul_f32 v28, v28, v56
    v_mul_f32 v29, v29, v56
    v_mul_f32 v30, v30, v56
    v_mul_f32 v31, v31, v56
    v_mul_f32 v32, v32, v56
    v_mul_f32 v33, v33, v56
    v_mul_f32 v34, v34, v56
    v_mul_f32 v35, v35, v56
    v_mul_f32 v36, v36, v56
    v_mul_f32 v37, v37, v56
    v_mul_f32 v38, v38, v56
    v_mul_f32 v39, v39, v56
    v_mul_f32 v40, v40, v56
    v_mul_f32 v41, v41, v56
    v_mul_f32 v42, v42, v56
    v_mul_f32 v43, v43, v56
    v_mul_f32 v44, v44, v56
    v_mul_f32 v45, v45, v56
    v_mul_f32 v46, v46, v56
    v_mul_f32 v47, v47, v56
    v_mul_f32 v48, v48, v56
    v_mul_f32 v49, v49, v56
    v_mul_f32 v50, v50, v56
    v_mul_f32 v51, v51, v56
    s_branch L_rsrets3
L_rss4:
    v_max_f32 v55, v52, v54
    v_sub_f32 v56, v52, v55
    v_mul_f32 v56, s41, v56
    v_exp_f32 v56, v56
    v_mov_b32 v52, v55
    v_mul_f32 v53, v53, v56
    v_mul_f32 v28, v28, v56
    v_mul_f32 v29, v29, v56
    v_mul_f32 v30, v30, v56
    v_mul_f32 v31, v31, v56
    v_mul_f32 v32, v32, v56
    v_mul_f32 v33, v33, v56
    v_mul_f32 v34, v34, v56
    v_mul_f32 v35, v35, v56
    v_mul_f32 v36, v36, v56
    v_mul_f32 v37, v37, v56
    v_mul_f32 v38, v38, v56
    v_mul_f32 v39, v39, v56
    v_mul_f32 v40, v40, v56
    v_mul_f32 v41, v41, v56
    v_mul_f32 v42, v42, v56
    v_mul_f32 v43, v43, v56
    v_mul_f32 v44, v44, v56
    v_mul_f32 v45, v45, v56
    v_mul_f32 v46, v46, v56
    v_mul_f32 v47, v47, v56
    v_mul_f32 v48, v48, v56
    v_mul_f32 v49, v49, v56
    v_mul_f32 v50, v50, v56
    v_mul_f32 v51, v51, v56
    s_branch L_rsrets4
L_rss5:
    v_max_f32 v55, v52, v54
    v_sub_f32 v56, v52, v55
    v_mul_f32 v56, s41, v56
    v_exp_f32 v56, v56
    v_mov_b32 v52, v55
    v_mul_f32 v53, v53, v56
    v_mul_f32 v28, v28, v56
    v_mul_f32 v29, v29, v56
    v_mul_f32 v30, v30, v56
    v_mul_f32 v31, v31, v56
    v_mul_f32 v32, v32, v56
    v_mul_f32 v33, v33, v56
    v_mul_f32 v34, v34, v56
    v_mul_f32 v35, v35, v56
    v_mul_f32 v36, v36, v56
    v_mul_f32 v37, v37, v56
    v_mul_f32 v38, v38, v56
    v_mul_f32 v39, v39, v56
    v_mul_f32 v40, v40, v56
    v_mul_f32 v41, v41, v56
    v_mul_f32 v42, v42, v56
    v_mul_f32 v43, v43, v56
    v_mul_f32 v44, v44, v56
    v_mul_f32 v45, v45, v56
    v_mul_f32 v46, v46, v56
    v_mul_f32 v47, v47, v56
    v_mul_f32 v48, v48, v56
    v_mul_f32 v49, v49, v56
    v_mul_f32 v50, v50, v56
    v_mul_f32 v51, v51, v56
    s_branch L_rsrets5
L_twm0:
    s_mov_b32 s36, 0
L_twlm0:
    s_sleep 1
    ds_read_b32 v6, v7
    s_waitcnt lgkmcnt(0)
    v_readfirstlane_b32 s70, v6
    s_cmp_lg_u32 s70, -1
    s_cbranch_scc1 L_twretm0
    s_add_u32 s36, s36, 1
    s_cmp_lt_u32 s36, 80000
    s_cbranch_scc1 L_twlm0
    s_mov_b32 s70, 0x7fffffff
    s_branch L_twretm0
L_rsm0:
    v_max_f32 v55, v52, v54
    v_sub_f32 v56, v52, v55
    v_mul_f32 v56, s41, v56
    v_exp_f32 v56, v56
    v_mov_b32 v52, v55
    v_mul_f32 v53, v53, v56
    v_mul_f32 v28, v28, v56
    v_mul_f32 v29, v29, v56
    v_mul_f32 v30, v30, v56
    v_mul_f32 v31, v31, v56
    v_mul_f32 v32, v32, v56
    v_mul_f32 v33, v33, v56
    v_mul_f32 v34, v34, v56
    v_mul_f32 v35, v35, v56
    v_mul_f32 v36, v36, v56
    v_mul_f32 v37, v37, v56
    v_mul_f32 v38, v38, v56
    v_mul_f32 v39, v39, v56
    v_mul_f32 v40, v40, v56
    v_mul_f32 v41, v41, v56
    v_mul_f32 v42, v42, v56
    v_mul_f32 v43, v43, v56
    v_mul_f32 v44, v44, v56
    v_mul_f32 v45, v45, v56
    v_mul_f32 v46, v46, v56
    v_mul_f32 v47, v47, v56
    v_mul_f32 v48, v48, v56
    v_mul_f32 v49, v49, v56
    v_mul_f32 v50, v50, v56
    v_mul_f32 v51, v51, v56
    s_branch L_rsretm0
L_sw0:
    v_mov_b32 v54, v52
    s_nop 1
    v_max_f32_dpp v54, v54, v54 row_ror:8 row_mask:0xf bank_mask:0xf
    v_mov_b32 v55, v54
    s_nop 1
    v_permlane16_swap_b32 v54, v55
    v_max_f32 v54, v54, v55
    v_mov_b32 v55, v54
    s_nop 1
    v_permlane32_swap_b32 v54, v55
    v_max_f32 v54, v54, v55
    v_sub_f32 v56, v52, v54
    v_mul_f32 v56, s41, v56
    v_exp_f32 v56, v56
    s_nop 0
    v_mul_f32 v57, v53, v56
    v_mul_f32 v28, v28, v56
    v_mul_f32 v29, v29, v56
    v_mul_f32 v30, v30, v56
    v_mul_f32 v31, v31, v56
    v_mul_f32 v32, v32, v56
    v_mul_f32 v33, v33, v56
    v_mul_f32 v34, v34, v56
    v_mul_f32 v35, v35, v56
    v_mul_f32 v36, v36, v56
    v_mul_f32 v37, v37, v56
    v_mul_f32 v38, v38, v56
    v_mul_f32 v39, v39, v56
    v_mul_f32 v40, v40, v56
    v_mul_f32 v41, v41, v56
    v_mul_f32 v42, v42, v56
    v_mul_f32 v43, v43, v56
    v_mul_f32 v44, v44, v56
    v_mul_f32 v45, v45, v56
    v_mul_f32 v46, v46, v56
    v_mul_f32 v47, v47, v56
    v_mul_f32 v48, v48, v56
    v_mul_f32 v49, v49, v56
    v_mul_f32 v50, v50, v56
    v_mul_f32 v51, v51, v56
    v_add_f32_dpp v57, v57, v57 row_ror:8 row_mask:0xf bank_mask:0xf
    v_mov_b32 v55, v57
    s_nop 1
    v_permlane16_swap_b32 v57, v55
    v_add_f32 v57, v57, v55
    v_mov_b32 v55, v57
    s_nop 1
    v_permlane32_swap_b32 v57, v55
    v_add_f32 v57, v57, v55
    v_permlane32_swap_b32 v28, v32
    v_permlane32_swap_b32 v29, v33
    v_permlane32_swap_b32 v30, v34
    v_permlane32_swap_b32 v31, v35
    v_permlane32_swap_b32 v36, v40
    v_permlane32_swap_b32 v37, v41
    v_permlane32_swap_b32 v38, v42
    v_permlane32_swap_b32 v39, v43
    v_permlane32_swap_b32 v44, v48
    v_permlane32_swap_b32 v45, v49
    v_permlane32_swap_b32 v46, v50
    v_permlane32_swap_b32 v47, v51
    v_add_f32 v28, v28, v32
    v_add_f32 v29, v29, v33
    v_add_f32 v30, v30, v34
    v_add_f32 v31, v31, v35
    v_add_f32 v36, v36, v40
    v_add_f32 v37, v37, v41
    v_add_f32 v38, v38, v42
    v_add_f32 v39, v39, v43
    v_add_f32 v44, v44, v48
    v_add_f32 v45, v45, v49
    v_add_f32 v46, v46, v50
    v_add_f32 v47, v47, v51
    v_permlane16_swap_b32 v28, v30
    v_permlane16_swap_b32 v29, v31
    v_permlane16_swap_b32 v36, v38
    v_permlane16_swap_b32 v37, v39
    v_permlane16_swap_b32 v44, v46
    v_permlane16_swap_b32 v45, v47
    v_add_f32 v28, v28, v30
    v_add_f32 v29, v29, v31
    v_add_f32 v36, v36, v38
    v_add_f32 v37, v37, v39
    v_add_f32 v44, v44, v46
    v_add_f32 v45, v45, v47
    v_add_f32_dpp v28, v28, v28 row_ror:8 row_mask:0xf bank_mask:0x3
    v_add_f32_dpp v36, v36, v36 row_ror:8 row_mask:0xf bank_mask:0x3
    v_add_f32_dpp v44, v44, v44 row_ror:8 row_mask:0xf bank_mask:0x3
    v_add_f32_dpp v28, v29, v29 row_ror:8 row_mask:0xf bank_mask:0xc
    v_add_f32_dpp v36, v37, v37 row_ror:8 row_mask:0xf bank_mask:0xc
    v_add_f32_dpp v44, v45, v45 row_ror:8 row_mask:0xf bank_mask:0xc
    s_lshl_b32 s33, s3, 2
    s_add_u32 s33, s33, s31
    s_mul_i32 s33, s33, 784
    s_add_u32 s33, s33, 0
    v_add_u32 v55, s33, v14
    ds_write_b32 v55, v28 offset:0
    ds_write_b32 v55, v36 offset:256
    ds_write_b32 v55, v44 offset:512
    v_mov_b32 v55, s33
    v_mov_b32 v58, v54
    v_mov_b32 v59, v57
    s_mov_b64 exec, 1
    ds_write_b64 v55, v[58:59] offset:768
    s_mov_b64 exec, -1
    s_lshr_b32 s31, s70, 10
    s_mul_i32 s33, s31, 384
    v_add_u32 v54, s33, v15
    ds_read_b128 v[16:19], v54 offset:0
    ds_read_b128 v[20:23], v54 offset:128
    ds_read_b128 v[24:27], v54 offset:256
    v_mov_b32 v28, 0
    v_mov_b32 v29, 0
    v_mov_b32 v30, 0
    v_mov_b32 v31, 0
    v_mov_b32 v32, 0
    v_mov_b32 v33, 0
    v_mov_b32 v34, 0
    v_mov_b32 v35, 0
    v_mov_b32 v36, 0
    v_mov_b32 v37, 0
    v_mov_b32 v38, 0
    v_mov_b32 v39, 0
    v_mov_b32 v40, 0
    v_mov_b32 v41, 0
    v_mov_b32 v42, 0
    v_mov_b32 v43, 0
    v_mov_b32 v44, 0
    v_mov_b32 v45, 0
    v_mov_b32 v46, 0
    v_mov_b32 v47, 0
    v_mov_b32 v48, 0
    v_mov_b32 v49, 0
    v_mov_b32 v50, 0
    v_mov_b32 v51, 0
    v_mov_b32 v52, 0xf149f2ca
    v_mov_b32 v53, 0
    s_waitcnt lgkmcnt(0)
    s_cmp_eq_u32 s3, 7
    s_cbranch_scc1 L_warm1
    s_branch L_swret0
L_twm1:
    s_mov_b32 s36, 0
L_twlm1:
    s_sleep 1
    ds_read_b32 v6, v7
    s_waitcnt lgkmcnt(0)
    v_readfirstlane_b32 s71, v6
    s_cmp_lg_u32 s71, -1
    s_cbranch_scc1 L_twretm1
    s_add_u32 s36, s36, 1
    s_cmp_lt_u32 s36, 80000
    s_cbranch_scc1 L_twlm1
    s_mov_b32 s71, 0x7fffffff
    s_branch L_twretm1
L_rsm1:
    v_max_f32 v55, v52, v54
    v_sub_f32 v56, v52, v55
    v_mul_f32 v56, s41, v56
    v_exp_f32 v56, v56
    v_mov_b32 v52, v55
    v_mul_f32 v53, v53, v56
    v_mul_f32 v28, v28, v56
    v_mul_f32 v29, v29, v56
    v_mul_f32 v30, v30, v56
    v_mul_f32 v31, v31, v56
    v_mul_f32 v32, v32, v56
    v_mul_f32 v33, v33, v56
    v_mul_f32 v34, v34, v56
    v_mul_f32 v35, v35, v56
    v_mul_f32 v36, v36, v56
    v_mul_f32 v37, v37, v56
    v_mul_f32 v38, v38, v56
    v_mul_f32 v39, v39, v56
    v_mul_f32 v40, v40, v56
    v_mul_f32 v41, v41, v56
    v_mul_f32 v42, v42, v56
    v_mul_f32 v43, v43, v56
    v_mul_f32 v44, v44, v56
    v_mul_f32 v45, v45, v56
    v_mul_f32 v46, v46, v56
    v_mul_f32 v47, v47, v56
    v_mul_f32 v48, v48, v56
    v_mul_f32 v49, v49, v56
    v_mul_f32 v50, v50, v56
    v_mul_f32 v51, v51, v56
    s_branch L_rsretm1
L_sw1:
    v_mov_b32 v54, v52
    s_nop 1
    v_max_f32_dpp v54, v54, v54 row_ror:8 row_mask:0xf bank_mask:0xf
    v_mov_b32 v55, v54
    s_nop 1
    v_permlane16_swap_b32 v54, v55
    v_max_f32 v54, v54, v55
    v_mov_b32 v55, v54
    s_nop 1
    v_permlane32_swap_b32 v54, v55
    v_max_f32 v54, v54, v55
    v_sub_f32 v56, v52, v54
    v_mul_f32 v56, s41, v56
    v_exp_f32 v56, v56
    s_nop 0
    v_mul_f32 v57, v53, v56
    v_mul_f32 v28, v28, v56
    v_mul_f32 v29, v29, v56
    v_mul_f32 v30, v30, v56
    v_mul_f32 v31, v31, v56
    v_mul_f32 v32, v32, v56
    v_mul_f32 v33, v33, v56
    v_mul_f32 v34, v34, v56
    v_mul_f32 v35, v35, v56
    v_mul_f32 v36, v36, v56
    v_mul_f32 v37, v37, v56
    v_mul_f32 v38, v38, v56
    v_mul_f32 v39, v39, v56
    v_mul_f32 v40, v40, v56
    v_mul_f32 v41, v41, v56
    v_mul_f32 v42, v42, v56
    v_mul_f32 v43, v43, v56
    v_mul_f32 v44, v44, v56
    v_mul_f32 v45, v45, v56
    v_mul_f32 v46, v46, v56
    v_mul_f32 v47, v47, v56
    v_mul_f32 v48, v48, v56
    v_mul_f32 v49, v49, v56
    v_mul_f32 v50, v50, v56
    v_mul_f32 v51, v51, v56
    v_add_f32_dpp v57, v57, v57 row_ror:8 row_mask:0xf bank_mask:0xf
    v_mov_b32 v55, v57
    s_nop 1
    v_permlane16_swap_b32 v57, v55
    v_add_f32 v57, v57, v55
    v_mov_b32 v55, v57
    s_nop 1
    v_permlane32_swap_b32 v57, v55
    v_add_f32 v57, v57, v55
    v_permlane32_swap_b32 v28, v32
    v_permlane32_swap_b32 v29, v33
    v_permlane32_swap_b32 v30, v34
    v_permlane32_swap_b32 v31, v35
    v_permlane32_swap_b32 v36, v40
    v_permlane32_swap_b32 v37, v41
    v_permlane32_swap_b32 v38, v42
    v_permlane32_swap_b32 v39, v43
    v_permlane32_swap_b32 v44, v48
    v_permlane32_swap_b32 v45, v49
    v_permlane32_swap_b32 v46, v50
    v_permlane32_swap_b32 v47, v51
    v_add_f32 v28, v28, v32
    v_add_f32 v29, v29, v33
    v_add_f32 v30, v30, v34
    v_add_f32 v31, v31, v35
    v_add_f32 v36, v36, v40
    v_add_f32 v37, v37, v41
    v_add_f32 v38, v38, v42
    v_add_f32 v39, v39, v43
    v_add_f32 v44, v44, v48
    v_add_f32 v45, v45, v49
    v_add_f32 v46, v46, v50
    v_add_f32 v47, v47, v51
    v_permlane16_swap_b32 v28, v30
    v_permlane16_swap_b32 v29, v31
    v_permlane16_swap_b32 v36, v38
    v_permlane16_swap_b32 v37, v39
    v_permlane16_swap_b32 v44, v46
    v_permlane16_swap_b32 v45, v47
    v_add_f32 v28, v28, v30
    v_add_f32 v29, v29, v31
    v_add_f32 v36, v36, v38
    v_add_f32 v37, v37, v39
    v_add_f32 v44, v44, v46
    v_add_f32 v45, v45, v47
    v_add_f32_dpp v28, v28, v28 row_ror:8 row_mask:0xf bank_mask:0x3
    v_add_f32_dpp v36, v36, v36 row_ror:8 row_mask:0xf bank_mask:0x3
    v_add_f32_dpp v44, v44, v44 row_ror:8 row_mask:0xf bank_mask:0x3
    v_add_f32_dpp v28, v29, v29 row_ror:8 row_mask:0xf bank_mask:0xc
    v_add_f32_dpp v36, v37, v37 row_ror:8 row_mask:0xf bank_mask:0xc
    v_add_f32_dpp v44, v45, v45 row_ror:8 row_mask:0xf bank_mask:0xc
    s_lshl_b32 s33, s3, 2
    s_add_u32 s33, s33, s31
    s_mul_i32 s33, s33, 784
    s_add_u32 s33, s33, 0
    v_add_u32 v55, s33, v14
    ds_write_b32 v55, v28 offset:0
    ds_write_b32 v55, v36 offset:256
    ds_write_b32 v55, v44 offset:512
    v_mov_b32 v55, s33
    v_mov_b32 v58, v54
    v_mov_b32 v59, v57
    s_mov_b64 exec, 1
    ds_write_b64 v55, v[58:59] offset:768
    s_mov_b64 exec, -1
    s_lshr_b32 s31, s71, 10
    s_mul_i32 s33, s31, 384
    v_add_u32 v54, s33, v15
    ds_read_b128 v[16:19], v54 offset:0
    ds_read_b128 v[20:23], v54 offset:128
    ds_read_b128 v[24:27], v54 offset:256
    v_mov_b32 v28, 0
    v_mov_b32 v29, 0
    v_mov_b32 v30, 0
    v_mov_b32 v31, 0
    v_mov_b32 v32, 0
    v_mov_b32 v33, 0
    v_mov_b32 v34, 0
    v_mov_b32 v35, 0
    v_mov_b32 v36, 0
    v_mov_b32 v37, 0
    v_mov_b32 v38, 0
    v_mov_b32 v39, 0
    v_mov_b32 v40, 0
    v_mov_b32 v41, 0
    v_mov_b32 v42, 0
    v_mov_b32 v43, 0
    v_mov_b32 v44, 0
    v_mov_b32 v45, 0
    v_mov_b32 v46, 0
    v_mov_b32 v47, 0
    v_mov_b32 v48, 0
    v_mov_b32 v49, 0
    v_mov_b32 v50, 0
    v_mov_b32 v51, 0
    v_mov_b32 v52, 0xf149f2ca
    v_mov_b32 v53, 0
    s_waitcnt lgkmcnt(0)
    s_cmp_eq_u32 s3, 7
    s_cbranch_scc1 L_warm2
    s_branch L_swret1
L_srv0:
L_warm0:
    s_mov_b32 s70, 0
    s_branch L_sw0
L_warm1:
    s_mov_b32 s71, 0
    s_branch L_sw1
L_warm2:
    s_setprio 3
    s_mov_b32 s70, 32
    s_mov_b32 s77, 0
    s_mov_b32 s71, 704
    s_mov_b32 s36, 0
L_srv_sz:
    s_mov_b32 s35, 64
    s_mov_b32 s72, 28
    s_cmp_ge_u32 s71, 3072
    s_cselect_b32 s35, 16, s35
    s_cselect_b32 s72, 20, s72
    s_cmp_ge_u32 s71, 3712
    s_cselect_b32 s35, 8, s35
    s_cselect_b32 s72, 14, s72
    s_cmp_ge_u32 s71, 3968
    s_cselect_b32 s35, 6, s35
    s_cselect_b32 s72, 10, s72
L_srv:
    ds_read_b32 v54, v5
    s_waitcnt lgkmcnt(0)
    v_readfirstlane_b32 s33, v54
    s_sub_u32 s33, s70, s33
    s_cmp_lt_i32 s33, s72
    s_cbranch_scc1 L_srv_get
    s_add_u32 s36, s36, 1
    s_cmp_lt_u32 s36, 320000
    s_cbranch_scc0 L_srv_fin
    s_sleep 2
    s_branch L_srv
L_srv_get:
    v_mov_b32 v55, s35
    s_mov_b64 exec, 1
    global_atomic_add v56, v3, v55, s[66:67] sc0
    s_mov_b64 exec, -1
    s_lshl_b32 s34, s70, 2
    s_add_u32 s34, s34, 139536
    v_lshlrev_b32 v57, 2, v1
    v_add_u32 v57, s34, v57
    s_waitcnt vmcnt(0)
    v_readfirstlane_b32 s33, v56
    s_add_u32 s33, s33, 704
    s_nop 0
    v_add_u32 v58, s33, v1
    v_add_u32 v59, 0, v1
    v_cmp_gt_u32 vcc, s35, v59
    s_and_saveexec_b64 s[38:39], vcc
    s_cbranch_execz L_srvw0
    ds_write_b32 v57, v58 offset:0
L_srvw0:
    s_mov_b64 exec, s[38:39]
    s_add_u32 s70, s70, s35
    s_add_u32 s71, s33, s35
    s_cmp_lt_u32 s71, 4096
    s_cbranch_scc1 L_srv_sz
L_srv_fin:
    s_lshl_b32 s34, s70, 2
    s_add_u32 s34, s34, 139536
    v_lshlrev_b32 v57, 2, v1
    v_add_u32 v57, s34, v57
    v_mov_b32 v58, 0x7fffffff
    ds_write_b32 v57, v58
    s_setprio 0
L_exit:
    v_mov_b32 v62, 192
    global_load_dword v63, v62, s[64:65] sc1
    s_cmp_lt_u32 s5, 5
    s_cbranch_scc0 L_nowo
    v_mov_b32 v54, v52
    s_nop 1
    v_max_f32_dpp v54, v54, v54 row_ror:8 row_mask:0xf bank_mask:0xf
    v_mov_b32 v55, v54
    s_nop 1
    v_permlane16_swap_b32 v54, v55
    v_max_f32 v54, v54, v55
    v_mov_b32 v55, v54
    s_nop 1
    v_permlane32_swap_b32 v54, v55
    v_max_f32 v54, v54, v55
    v_sub_f32 v56, v52, v54
    v_mul_f32 v56, s41, v56
    v_exp_f32 v56, v56
    s_nop 0
    v_mul_f32 v57, v53, v56
    v_mul_f32 v28, v28, v56
    v_mul_f32 v29, v29, v56
    v_mul_f32 v30, v30, v56
    v_mul_f32 v31, v31, v56
    v_mul_f32 v32, v32, v56
    v_mul_f32 v33, v33, v56
    v_mul_f32 v34, v34, v56
    v_mul_f32 v35, v35, v56
    v_mul_f32 v36, v36, v56
    v_mul_f32 v37, v37, v56
    v_mul_f32 v38, v38, v56
    v_mul_f32 v39, v39, v56
    v_mul_f32 v40, v40, v56
    v_mul_f32 v41, v41, v56
    v_mul_f32 v42, v42, v56
    v_mul_f32 v43, v43, v56
    v_mul_f32 v44, v44, v56
    v_mul_f32 v45, v45, v56
    v_mul_f32 v46, v46, v56
    v_mul_f32 v47, v47, v56
    v_mul_f32 v48, v48, v56
    v_mul_f32 v49, v49, v56
    v_mul_f32 v50, v50, v56
    v_mul_f32 v51, v51, v56
    v_add_f32_dpp v57, v57, v57 row_ror:8 row_mask:0xf bank_mask:0xf
    v_mov_b32 v55, v57
    s_nop 1
    v_permlane16_swap_b32 v57, v55
    v_add_f32 v57, v57, v55
    v_mov_b32 v55, v57
    s_nop 1
    v_permlane32_swap_b32 v57, v55
    v_add_f32 v57, v57, v55
    v_permlane32_swap_b32 v28, v32
    v_permlane32_swap_b32 v29, v33
    v_permlane32_swap_b32 v30, v34
    v_permlane32_swap_b32 v31, v35
    v_permlane32_swap_b32 v36, v40
    v_permlane32_swap_b32 v37, v41
    v_permlane32_swap_b32 v38, v42
    v_permlane32_swap_b32 v39, v43
    v_permlane32_swap_b32 v44, v48
    v_permlane32_swap_b32 v45, v49
    v_permlane32_swap_b32 v46, v50
    v_permlane32_swap_b32 v47, v51
    v_add_f32 v28, v28, v32
    v_add_f32 v29, v29, v33
    v_add_f32 v30, v30, v34
    v_add_f32 v31, v31, v35
    v_add_f32 v36, v36, v40
    v_add_f32 v37, v37, v41
    v_add_f32 v38, v38, v42
    v_add_f32 v39, v39, v43
    v_add_f32 v44, v44, v48
    v_add_f32 v45, v45, v49
    v_add_f32 v46, v46, v50
    v_add_f32 v47, v47, v51
    v_permlane16_swap_b32 v28, v30
    v_permlane16_swap_b32 v29, v31
    v_permlane16_swap_b32 v36, v38
    v_permlane16_swap_b32 v37, v39
    v_permlane16_swap_b32 v44, v46
    v_permlane16_swap_b32 v45, v47
    v_add_f32 v28, v28, v30
    v_add_f32 v29, v29, v31
    v_add_f32 v36, v36, v38
    v_add_f32 v37, v37, v39
    v_add_f32 v44, v44, v46
    v_add_f32 v45, v45, v47
    v_add_f32_dpp v28, v28, v28 row_ror:8 row_mask:0xf bank_mask:0x3
    v_add_f32_dpp v36, v36, v36 row_ror:8 row_mask:0xf bank_mask:0x3
    v_add_f32_dpp v44, v44, v44 row_ror:8 row_mask:0xf bank_mask:0x3
    v_add_f32_dpp v28, v29, v29 row_ror:8 row_mask:0xf bank_mask:0xc
    v_add_f32_dpp v36, v37, v37 row_ror:8 row_mask:0xf bank_mask:0xc
    v_add_f32_dpp v44, v45, v45 row_ror:8 row_mask:0xf bank_mask:0xc
    s_lshl_b32 s33, s3, 2
    s_add_u32 s33, s33, s31
    s_mul_i32 s33, s33, 784
    s_add_u32 s33, s33, 0
    v_add_u32 v55, s33, v14
    ds_write_b32 v55, v28 offset:0
    ds_write_b32 v55, v36 offset:256
    ds_write_b32 v55, v44 offset:512
    v_mov_b32 v55, s33
    v_mov_b32 v58, v54
    v_mov_b32 v59, v57
    s_mov_b64 exec, 1
    ds_write_b64 v55, v[58:59] offset:768
    s_mov_b64 exec, -1
    s_mov_b32 s20, s52
    s_mov_b32 s21, s53
    s_mov_b32 s22, 7864320
    s_mov_b32 s23, 0x20000
    v_lshrrev_b32 v56, 4, v1
    v_and_b32 v55, 15, v1
    v_lshlrev_b32 v57, 1, v56
    v_xor_b32 v55, v55, v57
    s_and_b32 s33, s3, 1
    s_lshl_b32 s33, s33, 3
    v_xor_b32 v55, s33, v55
    v_mul_u32_u24 v56, 1280, v56
    v_xor_b32 v57, 8, v55
    v_lshlrev_b32 v55, 4, v55
    v_lshlrev_b32 v57, 4, v57
    v_add_u32 v60, v56, v55
    v_add_u32 v61, v56, v57
    s_mul_i32 s33, s3, 24
    s_mul_i32 s34, s4, 192
    s_add_u32 s34, s34, s33
    s_mul_i32 s34, s34, 1280
    s_lshl_b32 s35, s5, 8
    s_add_u32 s34, s34, s35
    s_lshl_b32 s33, s33, 8
    s_add_u32 s33, s33, 81920
    s_mov_b32 m0, s33
    s_nop 0
    buffer_load_dwordx4 v60, s[20:23], s34 offen nt lds
    s_add_u32 s33, s33, 1024
    s_add_u32 s34, s34, 5120
    s_mov_b32 m0, s33
    s_nop 0
    buffer_load_dwordx4 v60, s[20:23], s34 offen nt lds
    s_add_u32 s33, s33, 1024
    s_add_u32 s34, s34, 5120
    s_mov_b32 m0, s33
    s_nop 0
    buffer_load_dwordx4 v61, s[20:23], s34 offen nt lds
    s_add_u32 s33, s33, 1024
    s_add_u32 s34, s34, 5120
    s_mov_b32 m0, s33
    s_nop 0
    buffer_load_dwordx4 v61, s[20:23], s34 offen nt lds
    s_add_u32 s33, s33, 1024
    s_add_u32 s34, s34, 5120
    s_mov_b32 m0, s33
    s_nop 0
    buffer_load_dwordx4 v60, s[20:23], s34 offen nt lds
    s_add_u32 s33, s33, 1024
    s_add_u32 s34, s34, 5120
    s_mov_b32 m0, s33
    s_nop 0
    buffer_load_dwordx4 v60, s[20:23], s34 offen nt lds
    s_waitcnt lgkmcnt(0)
    s_barrier
    s_waitcnt vmcnt(6)
    s_branch L_b4done
L_nowo:
    v_mov_b32 v54, v52
    s_nop 1
    v_max_f32_dpp v54, v54, v54 row_ror:8 row_mask:0xf bank_mask:0xf
    v_mov_b32 v55, v54
    s_nop 1
    v_permlane16_swap_b32 v54, v55
    v_max_f32 v54, v54, v55
    v_mov_b32 v55, v54
    s_nop 1
    v_permlane32_swap_b32 v54, v55
    v_max_f32 v54, v54, v55
    v_sub_f32 v56, v52, v54
    v_mul_f32 v56, s41, v56
    v_exp_f32 v56, v56
    s_nop 0
    v_mul_f32 v57, v53, v56
    v_mul_f32 v28, v28, v56
    v_mul_f32 v29, v29, v56
    v_mul_f32 v30, v30, v56
    v_mul_f32 v31, v31, v56
    v_mul_f32 v32, v32, v56
    v_mul_f32 v33, v33, v56
    v_mul_f32 v34, v34, v56
    v_mul_f32 v35, v35, v56
    v_mul_f32 v36, v36, v56
    v_mul_f32 v37, v37, v56
    v_mul_f32 v38, v38, v56
    v_mul_f32 v39, v39, v56
    v_mul_f32 v40, v40, v56
    v_mul_f32 v41, v41, v56
    v_mul_f32 v42, v42, v56
    v_mul_f32 v43, v43, v56
    v_mul_f32 v44, v44, v56
    v_mul_f32 v45, v45, v56
    v_mul_f32 v46, v46, v56
    v_mul_f32 v47, v47, v56
    v_mul_f32 v48, v48, v56
    v_mul_f32 v49, v49, v56
    v_mul_f32 v50, v50, v56
    v_mul_f32 v51, v51, v56
    v_add_f32_dpp v57, v57, v57 row_ror:8 row_mask:0xf bank_mask:0xf
    v_mov_b32 v55, v57
    s_nop 1
    v_permlane16_swap_b32 v57, v55
    v_add_f32 v57, v57, v55
    v_mov_b32 v55, v57
    s_nop 1
    v_permlane32_swap_b32 v57, v55
    v_add_f32 v57, v57, v55
    v_permlane32_swap_b32 v28, v32
    v_permlane32_swap_b32 v29, v33
    v_permlane32_swap_b32 v30, v34
    v_permlane32_swap_b32 v31, v35
    v_permlane32_swap_b32 v36, v40
    v_permlane32_swap_b32 v37, v41
    v_permlane32_swap_b32 v38, v42
    v_permlane32_swap_b32 v39, v43
    v_permlane32_swap_b32 v44, v48
    v_permlane32_swap_b32 v45, v49
    v_permlane32_swap_b32 v46, v50
    v_permlane32_swap_b32 v47, v51
    v_add_f32 v28, v28, v32
    v_add_f32 v29, v29, v33
    v_add_f32 v30, v30, v34
    v_add_f32 v31, v31, v35
    v_add_f32 v36, v36, v40
    v_add_f32 v37, v37, v41
    v_add_f32 v38, v38, v42
    v_add_f32 v39, v39, v43
    v_add_f32 v44, v44, v48
    v_add_f32 v45, v45, v49
    v_add_f32 v46, v46, v50
    v_add_f32 v47, v47, v51
    v_permlane16_swap_b32 v28, v30
    v_permlane16_swap_b32 v29, v31
    v_permlane16_swap_b32 v36, v38
    v_permlane16_swap_b32 v37, v39
    v_permlane16_swap_b32 v44, v46
    v_permlane16_swap_b32 v45, v47
    v_add_f32 v28, v28, v30
    v_add_f32 v29, v29, v31
    v_add_f32 v36, v36, v38
    v_add_f32 v37, v37, v39
    v_add_f32 v44, v44, v46
    v_add_f32 v45, v45, v47
    v_add_f32_dpp v28, v28, v28 row_ror:8 row_mask:0xf bank_mask:0x3
    v_add_f32_dpp v36, v36, v36 row_ror:8 row_mask:0xf bank_mask:0x3
    v_add_f32_dpp v44, v44, v44 row_ror:8 row_mask:0xf bank_mask:0x3
    v_add_f32_dpp v28, v29, v29 row_ror:8 row_mask:0xf bank_mask:0xc
    v_add_f32_dpp v36, v37, v37 row_ror:8 row_mask:0xf bank_mask:0xc
    v_add_f32_dpp v44, v45, v45 row_ror:8 row_mask:0xf bank_mask:0xc
    s_lshl_b32 s33, s3, 2
    s_add_u32 s33, s33, s31
    s_mul_i32 s33, s33, 784
    s_add_u32 s33, s33, 0
    v_add_u32 v55, s33, v14
    ds_write_b32 v55, v28 offset:0
    ds_write_b32 v55, v36 offset:256
    ds_write_b32 v55, v44 offset:512
    v_mov_b32 v55, s33
    v_mov_b32 v58, v54
    v_mov_b32 v59, v57
    s_mov_b64 exec, 1
    ds_write_b64 v55, v[58:59] offset:768
    s_mov_b64 exec, -1
    s_waitcnt lgkmcnt(0)
    s_barrier
    s_waitcnt vmcnt(0)
L_b4done:
    s_cmp_lt_u32 s5, 5
    s_cbranch_scc0 L_nopre
    v_lshrrev_b32 v24, 4, v1
    v_and_b32 v25, 15, v1
    v_lshrrev_b32 v26, 2, v25
    v_and_b32 v27, 3, v25
    v_lshlrev_b32 v48, 3, v24
    v_add_u32 v48, v48, v26
    v_lshlrev_b32 v48, 8, v48
    v_lshlrev_b32 v27, 3, v27
    v_add_u32 v48, v48, v27
    v_and_b32 v24, 1, v24
    v_lshlrev_b32 v24, 2, v24
    v_or_b32 v24, v24, v26
    v_xor_b32 v24, s3, v24
    v_lshlrev_b32 v24, 5, v24
    v_add_u32 v48, v48, v24
    v_add_u32 v48, 81920, v48
L_nopre:
    s_cmp_ge_u32 s3, 3
    s_cbranch_scc1 L_tail_hi
    v_mul_u32_u24 v16, 1366, v0
    v_lshrrev_b32 v16, 16, v16
    v_mul_u32_u24 v17, 48, v16
    v_sub_u32 v17, v0, v17
    v_mul_u32_u24 v18, 784, v16
    v_add_u32 v18, 0, v18
    v_lshlrev_b32 v19, 4, v17
    v_add_u32 v19, v18, v19
    ds_read_b64 v[20:21], v18 offset:768
    ds_read_b64 v[22:23], v18 offset:3904
    ds_read_b64 v[24:25], v18 offset:7040
    ds_read_b64 v[26:27], v18 offset:10176
    ds_read_b64 v[28:29], v18 offset:13312
    ds_read_b64 v[30:31], v18 offset:16448
    ds_read_b64 v[32:33], v18 offset:19584
    ds_read_b64 v[34:35], v18 offset:22720
    ds_read_b128 v[96:99], v19 offset:0
    ds_read_b128 v[100:103], v19 offset:3136
    ds_read_b128 v[104:107], v19 offset:6272
    ds_read_b128 v[108:111], v19 offset:9408
    ds_read_b128 v[112:115], v19 offset:12544
    ds_read_b128 v[116:119], v19 offset:15680
    ds_read_b128 v[120:123], v19 offset:18816
    s_waitcnt lgkmcnt(7)
    ds_read_b128 v[124:127], v19 offset:21952
    v_max3_f32 v36, v20, v22, v24
    v_max3_f32 v36, v36, v26, v28
    v_max3_f32 v36, v36, v30, v32
    v_max_f32 v36, v36, v34
    v_sub_f32 v20, v20, v36
    v_sub_f32 v22, v22, v36
    v_sub_f32 v24, v24, v36
    v_sub_f32 v26, v26, v36
    v_sub_f32 v28, v28, v36
    v_sub_f32 v30, v30, v36
    v_sub_f32 v32, v32, v36
    v_sub_f32 v34, v34, v36
    v_mul_f32 v20, s41, v20
    v_mul_f32 v22, s41, v22
    v_mul_f32 v24, s41, v24
    v_mul_f32 v26, s41, v26
    v_mul_f32 v28, s41, v28
    v_mul_f32 v30, s41, v30
    v_mul_f32 v32, s41, v32
    v_mul_f32 v34, s41, v34
    v_exp_f32 v20, v20
    v_exp_f32 v22, v22
    v_exp_f32 v24, v24
    v_exp_f32 v26, v26
    v_exp_f32 v28, v28
    v_exp_f32 v30, v30
    v_exp_f32 v32, v32
    v_exp_f32 v34, v34
    v_mul_f32 v37, v20, v21
    v_fmac_f32 v37, v22, v23
    v_fmac_f32 v37, v24, v25
    v_fmac_f32 v37, v26, v27
    v_fmac_f32 v37, v28, v29
    v_fmac_f32 v37, v30, v31
    v_fmac_f32 v37, v32, v33
    v_fmac_f32 v37, v34, v35
    s_waitcnt lgkmcnt(0)
    v_mul_f32 v40, v20, v96
    v_mul_f32 v41, v20, v97
    v_mul_f32 v42, v20, v98
    v_mul_f32 v43, v20, v99
    v_fmac_f32 v40, v22, v100
    v_fmac_f32 v41, v22, v101
    v_fmac_f32 v42, v22, v102
    v_fmac_f32 v43, v22, v103
    v_fmac_f32 v40, v24, v104
    v_fmac_f32 v41, v24, v105
    v_fmac_f32 v42, v24, v106
    v_fmac_f32 v43, v24, v107
    v_fmac_f32 v40, v26, v108
    v_fmac_f32 v41, v26, v109
    v_fmac_f32 v42, v26, v110
    v_fmac_f32 v43, v26, v111
    v_fmac_f32 v40, v28, v112
    v_fmac_f32 v41, v28, v113
    v_fmac_f32 v42, v28, v114
    v_fmac_f32 v43, v28, v115
    v_fmac_f32 v40, v30, v116
    v_fmac_f32 v41, v30, v117
    v_fmac_f32 v42, v30, v118
    v_fmac_f32 v43, v30, v119
    v_fmac_f32 v40, v32, v120
    v_fmac_f32 v41, v32, v121
    v_fmac_f32 v42, v32, v122
    v_fmac_f32 v43, v32, v123
    v_fmac_f32 v40, v34, v124
    v_fmac_f32 v41, v34, v125
    v_fmac_f32 v42, v34, v126
    v_fmac_f32 v43, v34, v127
    s_lshl_b32 s33, s4, 3
    s_add_u32 s33, s33, s5
    s_mul_i32 s33, s33, 3200
    s_add_u32 s33, s33, 180224
    v_mul_u32_u24 v18, 800, v16
    v_lshlrev_b32 v19, 4, v17
    v_add_u32 v19, v18, v19
    buffer_store_dwordx4 v[40:43], v19, s[16:19], s33 offen sc1
    v_mov_b32 v38, 0
    v_mov_b32 v39, 0
    v_cmp_eq_u32 vcc, 0, v17
    s_and_saveexec_b64 s[38:39], vcc
    s_cbranch_execz L_noml
    buffer_store_dwordx4 v[36:39], v18, s[16:19], s33 offen offset:768 sc1
L_noml:
    s_mov_b64 exec, s[38:39]
    s_cmp_lt_u32 s5, 5
    s_cbranch_scc0 L_END2
    v_readfirstlane_b32 s33, v63
    s_cmp_eq_u32 s33, 256
    s_cbranch_scc1 L_clrA_ok
    s_mov_b32 s36, 0
    v_mov_b32 v62, 192
L_clrA:
    global_load_dword v63, v62, s[64:65] sc1
    s_waitcnt vmcnt(0)
    v_cmp_ne_u32 vcc, 0x100, v63
    s_cbranch_vccz L_clrA_ok
    s_add_u32 s36, s36, 1
    s_cmp_lt_u32 s36, 40000
    s_cbranch_scc0 L_clrA_ok
    s_sleep 2
    s_branch L_clrA
L_clrA_ok:
    s_mul_i32 s33, s4, 25600
    s_add_u32 s33, s33, 180224
    s_mov_b32 s36, 0
L_g1:
    s_mov_b32 s34, s33
    buffer_load_dwordx4 v[96:99], v19, s[16:19], s34 offen sc1
    buffer_load_dwordx2 v[20:21], v18, s[16:19], s34 offen offset:768 sc1
    s_add_u32 s34, s34, 3200
    buffer_load_dwordx4 v[100:103], v19, s[16:19], s34 offen sc1
    buffer_load_dwordx2 v[22:23], v18, s[16:19], s34 offen offset:768 sc1
    s_add_u32 s34, s34, 3200
    buffer_load_dwordx4 v[104:107], v19, s[16:19], s34 offen sc1
    buffer_load_dwordx2 v[24:25], v18, s[16:19], s34 offen offset:768 sc1
    s_add_u32 s34, s34, 3200
    buffer_load_dwordx4 v[108:111], v19, s[16:19], s34 offen sc1
    buffer_load_dwordx2 v[26:27], v18, s[16:19], s34 offen offset:768 sc1
    s_add_u32 s34, s34, 3200
    buffer_load_dwordx4 v[112:115], v19, s[16:19], s34 offen sc1
    buffer_load_dwordx2 v[28:29], v18, s[16:19], s34 offen offset:768 sc1
    s_add_u32 s34, s34, 3200
    buffer_load_dwordx4 v[116:119], v19, s[16:19], s34 offen sc1
    buffer_load_dwordx2 v[30:31], v18, s[16:19], s34 offen offset:768 sc1
    s_add_u32 s34, s34, 3200
    buffer_load_dwordx4 v[120:123], v19, s[16:19], s34 offen sc1
    buffer_load_dwordx2 v[32:33], v18, s[16:19], s34 offen offset:768 sc1
    s_add_u32 s34, s34, 3200
    buffer_load_dwordx4 v[124:127], v19, s[16:19], s34 offen sc1
    buffer_load_dwordx2 v[34:35], v18, s[16:19], s34 offen offset:768 sc1
    s_waitcnt vmcnt(0)
    v_max3_u32 v36, v96, v97, v98
    v_max3_u32 v36, v36, v99, v100
    v_max3_u32 v36, v36, v101, v102
    v_max3_u32 v36, v36, v103, v104
    v_max3_u32 v36, v36, v105, v106
    v_max3_u32 v36, v36, v107, v108
    v_max3_u32 v36, v36, v109, v110
    v_max3_u32 v36, v36, v111, v112
    v_max3_u32 v36, v36, v113, v114
    v_max3_u32 v36, v36, v115, v116
    v_max3_u32 v36, v36, v117, v118
    v_max3_u32 v36, v36, v119, v120
    v_max3_u32 v36, v36, v121, v122
    v_max3_u32 v36, v36, v123, v124
    v_max3_u32 v36, v36, v125, v126
    v_max_u32 v36, v36, v127
    v_max3_u32 v36, v36, v20, v21
    v_max3_u32 v36, v36, v22, v23
    v_max3_u32 v36, v36, v24, v25
    v_max3_u32 v36, v36, v26, v27
    v_max3_u32 v36, v36, v28, v29
    v_max3_u32 v36, v36, v30, v31
    v_max3_u32 v36, v36, v32, v33
    v_max3_u32 v36, v36, v34, v35
    v_cmp_eq_u32 vcc, -1, v36
    s_cbranch_vccz L_g1_ok
    s_add_u32 s36, s36, 1
    s_cmp_lt_u32 s36, 40000
    s_cbranch_scc0 L_g1_ok
    s_sleep 1
    s_branch L_g1
L_g1_ok:
    v_max3_f32 v36, v20, v22, v24
    v_max3_f32 v36, v36, v26, v28
    v_max3_f32 v36, v36, v30, v32
    v_max_f32 v36, v36, v34
    v_sub_f32 v20, v20, v36
    v_sub_f32 v22, v22, v36
    v_sub_f32 v24, v24, v36
    v_sub_f32 v26, v26, v36
    v_sub_f32 v28, v28, v36
    v_sub_f32 v30, v30, v36
    v_sub_f32 v32, v32, v36
    v_sub_f32 v34, v34, v36
    v_mul_f32 v20, s41, v20
    v_mul_f32 v22, s41, v22
    v_mul_f32 v24, s41, v24
    v_mul_f32 v26, s41, v26
    v_mul_f32 v28, s41, v28
    v_mul_f32 v30, s41, v30
    v_mul_f32 v32, s41, v32
    v_mul_f32 v34, s41, v34
    v_exp_f32 v20, v20
    v_exp_f32 v22, v22
    v_exp_f32 v24, v24
    v_exp_f32 v26, v26
    v_exp_f32 v28, v28
    v_exp_f32 v30, v30
    v_exp_f32 v32, v32
    v_exp_f32 v34, v34
    v_mul_f32 v37, v20, v21
    v_fmac_f32 v37, v22, v23
    v_fmac_f32 v37, v24, v25
    v_fmac_f32 v37, v26, v27
    v_fmac_f32 v37, v28, v29
    v_fmac_f32 v37, v30, v31
    v_fmac_f32 v37, v32, v33
    v_fmac_f32 v37, v34, v35
    v_mul_f32 v40, v20, v96
    v_mul_f32 v41, v20, v97
    v_mul_f32 v42, v20, v98
    v_mul_f32 v43, v20, v99
    v_fmac_f32 v40, v22, v100
    v_fmac_f32 v41, v22, v101
    v_fmac_f32 v42, v22, v102
    v_fmac_f32 v43, v22, v103
    v_fmac_f32 v40, v24, v104
    v_fmac_f32 v41, v24, v105
    v_fmac_f32 v42, v24, v106
    v_fmac_f32 v43, v24, v107
    v_fmac_f32 v40, v26, v108
    v_fmac_f32 v41, v26, v109
    v_fmac_f32 v42, v26, v110
    v_fmac_f32 v43, v26, v111
    v_fmac_f32 v40, v28, v112
    v_fmac_f32 v41, v28, v113
    v_fmac_f32 v42, v28, v114
    v_fmac_f32 v43, v28, v115
    v_fmac_f32 v40, v30, v116
    v_fmac_f32 v41, v30, v117
    v_fmac_f32 v42, v30, v118
    v_fmac_f32 v43, v30, v119
    v_fmac_f32 v40, v32, v120
    v_fmac_f32 v41, v32, v121
    v_fmac_f32 v42, v32, v122
    v_fmac_f32 v43, v32, v123
    v_fmac_f32 v40, v34, v124
    v_fmac_f32 v41, v34, v125
    v_fmac_f32 v42, v34, v126
    v_fmac_f32 v43, v34, v127
    v_rcp_f32 v38, v37
    s_nop 0
    v_mul_f32 v44, v40, v38
    v_fma_f32 v45, -v44, v37, v40
    v_fma_f32 v40, v45, v38, v44
    v_mul_f32 v44, v41, v38
    v_fma_f32 v45, -v44, v37, v41
    v_fma_f32 v41, v45, v38, v44
    v_mul_f32 v44, v42, v38
    v_fma_f32 v45, -v44, v37, v42
    v_fma_f32 v42, v45, v38, v44
    v_mul_f32 v44, v43, v38
    v_fma_f32 v45, -v44, v37, v43
    v_fma_f32 v43, v45, v38, v44
    v_cvt_pk_bf16_f32 v44, v40, v41
    v_cvt_pk_bf16_f32 v45, v42, v43
    v_mul_u32_u24 v18, 416, v16
    v_lshlrev_b32 v19, 3, v17
    v_add_u32 v18, v18, v19
    v_add_u32 v18, 137856, v18
    ds_write_b64 v18, v[44:45]
    s_waitcnt lgkmcnt(0)
    s_branch L_b5
L_tail_hi:
    s_cmp_lt_u32 s5, 5
    s_cbranch_scc1 L_b5w
    s_cmp_eq_u32 s3, 3
    s_cbranch_scc0 L_END2
    s_cmp_eq_u32 s5, 7
    s_cbranch_scc1 L_END2
    s_sub_u32 s33, s5, 5
    s_lshl_b32 s33, s33, 5
    s_add_u32 s33, s33, s4
    s_cmp_ge_u32 s33, 40
    s_cbranch_scc1 L_END2
    s_mul_i32 s34, s33, 205
    s_lshr_b32 s34, s34, 11
    s_mul_i32 s35, s34, 10
    s_sub_u32 s35, s33, s35
    s_mov_b32 s29, s34
    s_mov_b32 s28, s35
    v_readfirstlane_b32 s33, v63
    s_cmp_eq_u32 s33, 256
    s_cbranch_scc1 L_clrB_ok
    s_mov_b32 s36, 0
    v_mov_b32 v62, 192
L_clrB:
    global_load_dword v63, v62, s[64:65] sc1
    s_waitcnt vmcnt(0)
    v_cmp_ne_u32 vcc, 0x100, v63
    s_cbranch_vccz L_clrB_ok
    s_add_u32 s36, s36, 1
    s_cmp_lt_u32 s36, 40000
    s_cbranch_scc0 L_clrB_ok
    s_sleep 2
    s_branch L_clrB
L_clrB_ok:
    s_cmp_eq_u32 s4, 0
    s_cbranch_scc0 L_noeu
    s_cmp_eq_u32 s5, 5
    s_cbranch_scc0 L_noeu
    s_add_u32 s33, s68, 1
    s_add_u32 s34, s69, 0x9e3779b9
    v_mov_b32 v20, s33
    v_mov_b32 v21, s34
    v_mov_b32 v22, 4194048
    s_mov_b64 exec, 1
    global_store_dwordx2 v22, v[20:21], s[66:67] sc1
    s_mov_b64 exec, -1
L_noeu:
    s_mov_b32 s92, s44
    s_mov_b32 s93, s45
    s_mov_b32 s94, 5120
    s_mov_b32 s95, 0x20000
    s_mul_i32 s33, s29, 1280
    s_lshl_b32 s34, s28, 7
    s_add_u32 s26, s33, s34
    v_lshlrev_b32 v16, 1, v1
    buffer_load_ushort v17, v16, s[92:95], s26 offen
    v_lshlrev_b32 v18, 2, v1
    s_mul_i32 s33, s29, 2560
    s_lshl_b32 s34, s28, 8
    s_add_u32 s27, s33, s34
    s_mov_b32 s36, 0
L_gd:
    s_add_u32 s34, s27, 1327104
    buffer_load_dword v96, v18, s[16:19], s34 offen sc1
    s_add_u32 s34, s34, 10240
    buffer_load_dword v97, v18, s[16:19], s34 offen sc1
    s_add_u32 s34, s34, 10240
    buffer_load_dword v98, v18, s[16:19], s34 offen sc1
    s_waitcnt vmcnt(0)
    v_max3_u32 v36, v96, v97, v98
    v_cmp_eq_u32 vcc, -1, v36
    s_cbranch_vccz L_gd_ok
    s_add_u32 s36, s36, 1
    s_cmp_lt_u32 s36, 40000
    s_cbranch_scc0 L_gd_ok
    s_sleep 2
    s_branch L_gd
L_gd_ok:
    v_add_f32 v96, v96, v97
    v_add_f32 v96, v96, v98
    v_cvt_pk_bf16_f32 v96, v96, v96
    v_and_b32 v96, 0xffff0000, v96
    v_mul_f32 v20, 0xbfb8aa3b, v96
    v_exp_f32 v20, v20
    s_nop 0
    v_add_f32 v20, 1.0, v20
    v_rcp_f32 v21, v20
    s_nop 0
    v_mul_f32 v22, v96, v21
    v_fma_f32 v23, -v22, v20, v96
    v_fma_f32 v23, v23, v21, v22
    v_cmp_o_f32 vcc, v23, v23
    s_nop 1
    v_cndmask_b32 v22, v22, v23, vcc
    v_cvt_pk_bf16_f32 v22, v22, v22
    v_and_b32 v22, 0xffff0000, v22
    v_lshlrev_b32 v17, 16, v17
    s_mov_b32 s92, s62
    s_mov_b32 s93, s63
    s_mov_b32 s94, 5120
    s_mov_b32 s95, 0x20000
    s_mov_b32 s36, 0
L_g2:
    s_add_u32 s34, s27, 999424
    buffer_load_dword v64, v18, s[16:19], s34 offen sc1
    s_add_u32 s34, s34, 10240
    buffer_load_dword v65, v18, s[16:19], s34 offen sc1
    s_add_u32 s34, s34, 10240
    buffer_load_dword v66, v18, s[16:19], s34 offen sc1
    s_add_u32 s34, s34, 10240
    buffer_load_dword v67, v18, s[16:19], s34 offen sc1
    s_add_u32 s34, s34, 10240
    buffer_load_dword v68, v18, s[16:19], s34 offen sc1
    s_add_u32 s34, s34, 10240
    buffer_load_dword v69, v18, s[16:19], s34 offen sc1
    s_add_u32 s34, s34, 10240
    buffer_load_dword v70, v18, s[16:19], s34 offen sc1
    s_add_u32 s34, s34, 10240
    buffer_load_dword v71, v18, s[16:19], s34 offen sc1
    s_add_u32 s34, s34, 10240
    buffer_load_dword v72, v18, s[16:19], s34 offen sc1
    s_add_u32 s34, s34, 10240
    buffer_load_dword v73, v18, s[16:19], s34 offen sc1
    s_add_u32 s34, s34, 10240
    buffer_load_dword v74, v18, s[16:19], s34 offen sc1
    s_add_u32 s34, s34, 10240
    buffer_load_dword v75, v18, s[16:19], s34 offen sc1
    s_add_u32 s34, s34, 10240
    buffer_load_dword v76, v18, s[16:19], s34 offen sc1
    s_add_u32 s34, s34, 10240
    buffer_load_dword v77, v18, s[16:19], s34 offen sc1
    s_add_u32 s34, s34, 10240
    buffer_load_dword v78, v18, s[16:19], s34 offen sc1
    s_add_u32 s34, s34, 10240
    buffer_load_dword v79, v18, s[16:19], s34 offen sc1
    s_add_u32 s34, s34, 10240
    buffer_load_dword v80, v18, s[16:19], s34 offen sc1
    s_add_u32 s34, s34, 10240
    buffer_load_dword v81, v18, s[16:19], s34 offen sc1
    s_add_u32 s34, s34, 10240
    buffer_load_dword v82, v18, s[16:19], s34 offen sc1
    s_add_u32 s34, s34, 10240
    buffer_load_dword v83, v18, s[16:19], s34 offen sc1
    s_add_u32 s34, s34, 10240
    buffer_load_dword v84, v18, s[16:19], s34 offen sc1
    s_add_u32 s34, s34, 10240
    buffer_load_dword v85, v18, s[16:19], s34 offen sc1
    s_add_u32 s34, s34, 10240
    buffer_load_dword v86, v18, s[16:19], s34 offen sc1
    s_add_u32 s34, s34, 10240
    buffer_load_dword v87, v18, s[16:19], s34 offen sc1
    s_add_u32 s34, s34, 10240
    buffer_load_dword v88, v18, s[16:19], s34 offen sc1
    s_add_u32 s34, s34, 10240
    buffer_load_dword v89, v18, s[16:19], s34 offen sc1
    s_add_u32 s34, s34, 10240
    buffer_load_dword v90, v18, s[16:19], s34 offen sc1
    s_add_u32 s34, s34, 10240
    buffer_load_dword v91, v18, s[16:19], s34 offen sc1
    s_add_u32 s34, s34, 10240
    buffer_load_dword v92, v18, s[16:19], s34 offen sc1
    s_add_u32 s34, s34, 10240
    buffer_load_dword v93, v18, s[16:19], s34 offen sc1
    s_add_u32 s34, s34, 10240
    buffer_load_dword v94, v18, s[16:19], s34 offen sc1
    s_add_u32 s34, s34, 10240
    buffer_load_dword v95, v18, s[16:19], s34 offen sc1
    s_waitcnt vmcnt(0)
    v_max3_u32 v36, v64, v65, v66
    v_max3_u32 v36, v36, v67, v68
    v_max3_u32 v36, v36, v69, v70
    v_max3_u32 v36, v36, v71, v72
    v_max3_u32 v36, v36, v73, v74
    v_max3_u32 v36, v36, v75, v76
    v_max3_u32 v36, v36, v77, v78
    v_max3_u32 v36, v36, v79, v80
    v_max3_u32 v36, v36, v81, v82
    v_max3_u32 v36, v36, v83, v84
    v_max3_u32 v36, v36, v85, v86
    v_max3_u32 v36, v36, v87, v88
    v_max3_u32 v36, v36, v89, v90
    v_max3_u32 v36, v36, v91, v92
    v_max3_u32 v36, v36, v93, v94
    v_max_u32 v36, v36, v95
    v_cmp_eq_u32 vcc, -1, v36
    s_cbranch_vccz L_g2_ok
    s_add_u32 s36, s36, 1
    s_cmp_lt_u32 s36, 40000
    s_cbranch_scc0 L_g2_ok
    s_sleep 1
    s_branch L_g2
L_g2_ok:
    v_add_f32 v64, v64, v65
    v_add_f32 v66, v66, v67
    v_add_f32 v68, v68, v69
    v_add_f32 v70, v70, v71
    v_add_f32 v72, v72, v73
    v_add_f32 v74, v74, v75
    v_add_f32 v76, v76, v77
    v_add_f32 v78, v78, v79
    v_add_f32 v80, v80, v81
    v_add_f32 v82, v82, v83
    v_add_f32 v84, v84, v85
    v_add_f32 v86, v86, v87
    v_add_f32 v88, v88, v89
    v_add_f32 v90, v90, v91
    v_add_f32 v92, v92, v93
    v_add_f32 v94, v94, v95
    v_add_f32 v64, v64, v66
    v_add_f32 v68, v68, v70
    v_add_f32 v72, v72, v74
    v_add_f32 v76, v76, v78
    v_add_f32 v80, v80, v82
    v_add_f32 v84, v84, v86
    v_add_f32 v88, v88, v90
    v_add_f32 v92, v92, v94
    v_add_f32 v64, v64, v68
    v_add_f32 v72, v72, v76
    v_add_f32 v80, v80, v84
    v_add_f32 v88, v88, v92
    v_add_f32 v64, v64, v72
    v_add_f32 v80, v80, v88
    v_add_f32 v64, v64, v80
    v_cvt_pk_bf16_f32 v64, v64, v64
    v_and_b32 v64, 0xffff0000, v64
    v_mul_f32 v22, v64, v22
    v_cvt_pk_bf16_f32 v22, v22, v22
    v_and_b32 v22, 0xffff0000, v22
    v_add_f32 v22, v17, v22
    v_cvt_pk_bf16_f32 v22, v22, v22
    buffer_store_short v22, v16, s[92:95], s26 offen
    s_branch L_END2
    s_cmp_eq_u32 s4, 0
    s_cbranch_scc0 L_END2
    s_cmp_eq_u32 s5, 5
    s_cbranch_scc0 L_END2
    s_add_u32 s33, s68, 1
    s_add_u32 s34, s69, 0x9e3779b9
    v_mov_b32 v20, s33
    v_mov_b32 v21, s34
    v_mov_b32 v22, 4194048
    s_mov_b64 exec, 1
    global_store_dwordx2 v22, v[20:21], s[66:67] sc1
    s_mov_b64 exec, -1
    s_branch L_END2
L_b5w:
    s_waitcnt vmcnt(0) lgkmcnt(0)
L_b5:
    s_barrier
    v_and_b32 v16, 3, v1
    v_mul_u32_u24 v16, 416, v16
    v_lshrrev_b32 v17, 4, v1
    v_lshlrev_b32 v17, 4, v17
    v_add_u32 v16, v16, v17
    v_add_u32 v16, 137856, v16
    ds_read_b64_tr_b16 v[64:65], v48 offset:0
    ds_read_b64_tr_b16 v[66:67], v48 offset:1024
    ds_read_b128 v[96:99], v16 offset:0
    ds_read_b64_tr_b16 v[68:69], v48 offset:8192
    ds_read_b64_tr_b16 v[70:71], v48 offset:9216
    ds_read_b128 v[100:103], v16 offset:64
    ds_read_b64_tr_b16 v[72:73], v48 offset:16384
    ds_read_b64_tr_b16 v[74:75], v48 offset:17408
    ds_read_b128 v[104:107], v16 offset:128
    ds_read_b64_tr_b16 v[76:77], v48 offset:24576
    ds_read_b64_tr_b16 v[78:79], v48 offset:25600
    ds_read_b128 v[108:111], v16 offset:192
    ds_read_b64_tr_b16 v[80:81], v48 offset:32768
    ds_read_b64_tr_b16 v[82:83], v48 offset:33792
    ds_read_b128 v[112:115], v16 offset:256
    v_mov_b32 v20, 0
    v_mov_b32 v21, 0
    v_mov_b32 v22, 0
    v_mov_b32 v23, 0
    s_waitcnt lgkmcnt(12)
    s_nop 0
    v_mfma_f32_16x16x32_bf16 v[20:23], v[96:99], v[64:67], v[20:23]
    ds_read_b64_tr_b16 v[84:85], v48 offset:40960
    ds_read_b64_tr_b16 v[86:87], v48 offset:41984
    ds_read_b128 v[116:119], v16 offset:320
    s_waitcnt lgkmcnt(12)
    v_mfma_f32_16x16x32_bf16 v[20:23], v[100:103], v[68:71], v[20:23]
    s_waitcnt lgkmcnt(9)
    v_mfma_f32_16x16x32_bf16 v[20:23], v[104:107], v[72:75], v[20:23]
    s_waitcnt lgkmcnt(6)
    v_mfma_f32_16x16x32_bf16 v[20:23], v[108:111], v[76:79], v[20:23]
    s_waitcnt lgkmcnt(3)
    v_mfma_f32_16x16x32_bf16 v[20:23], v[112:115], v[80:83], v[20:23]
    s_waitcnt lgkmcnt(0)
    v_mfma_f32_16x16x32_bf16 v[20:23], v[116:119], v[84:87], v[20:23]
    s_mul_i32 s33, s4, 10240
    s_lshl_b32 s34, s5, 9
    s_add_u32 s33, s33, s34
    s_lshl_b32 s34, s3, 6
    s_add_u32 s33, s33, s34
    s_add_u32 s33, s33, 999424
    v_lshlrev_b32 v24, 2, v1
    s_mov_b64 exec, 0xffff
    buffer_store_dword v20, v24, s[16:19], s33 offen sc1
    s_add_u32 s33, s33, 2560
    buffer_store_dword v21, v24, s[16:19], s33 offen sc1
    s_add_u32 s33, s33, 2560
    buffer_store_dword v22, v24, s[16:19], s33 offen sc1
    s_add_u32 s33, s33, 2560
    buffer_store_dword v23, v24, s[16:19], s33 offen sc1
    s_mov_b64 exec, -1
L_END2:
    s_waitcnt vmcnt(0)
L_END:
    s_endpgm
.section .rodata,"a"
.p2align 6
.amdhsa_kernel recurrent_scan__mha_block_cached__geglu_ffn__decode_kernel
  .amdhsa_next_free_vgpr 256
  .amdhsa_next_free_sgpr 102
  .amdhsa_accum_offset 256
  .amdhsa_group_segment_fixed_size 0
  .amdhsa_kernarg_size 96
  .amdhsa_user_sgpr_count 2
  .amdhsa_user_sgpr_kernarg_segment_ptr 1
  .amdhsa_system_sgpr_workgroup_id_x 1
.end_amdhsa_kernel
```
